```python
import torch

def _softmax(x, axis=-1):
    return torch.softmax(x, dim=axis)
def _gelu(x):
    return torch.nn.functional.gelu(x, approximate="tanh")
def _silu(x):
    return torch.nn.functional.silu(x)
def _sigmoid(x):
    return torch.sigmoid(x)
def _layernorm(x, axis=-1, eps=1e-5):
    m = x.mean(dim=axis, keepdim=True)
    v = x.var(dim=axis, keepdim=True, unbiased=False)
    return (x - m) / torch.sqrt(v + eps)
def _scatter_add(tgt, idx, src, axis=0):
    return tgt.clone().index_add_(axis, idx, src)
def _segment_sum(src, seg, n):
    out = torch.zeros((n,) + src.shape[1:], dtype=src.dtype)
    return out.index_add_(0, seg, src)
def _pad(x, pw):
    flat = tuple(v for pair in reversed(pw) for v in pair)
    return torch.nn.functional.pad(x, flat)

kernel_name = 'gated_mix__ssm_conv_s5__ssm_conv_s4d__prompt'

def setup_inputs():

    _w = (lambda a: (lambda t: t.to(torch.bfloat16) if t.is_floating_point() else t)(torch.as_tensor(a)))
    def _A_setup():
        B, S, D = 1, 2048, 512
        P = D
        Lambda_re = -0.5 * (lambda _x: torch.exp(torch.as_tensor(_x)))((lambda *s: torch.randn(*s, dtype=torch.bfloat16) * 0.2)(P))
        Lambda_im = (lambda *s: torch.randn(*s, dtype=torch.bfloat16) * 0.4)(P) * 1.0
        B_re = (lambda *s: torch.randn(*s, dtype=torch.bfloat16) * 0.2)(P, D) * (D ** -0.5)
        B_im = (lambda *s: torch.randn(*s, dtype=torch.bfloat16) * 0.2)(P, D) * (D ** -0.5)
        C_re = (lambda *s: torch.randn(*s, dtype=torch.bfloat16) * 0.2)(D, P) * (P ** -0.5)
        C_im = (lambda *s: torch.randn(*s, dtype=torch.bfloat16) * 0.2)(D, P) * (P ** -0.5)
        log_dt = (lambda *s: torch.randn(*s, dtype=torch.bfloat16) * 0.2)(P) * 0.3 - 2.0
        Dskip = (lambda *s: torch.randn(*s, dtype=torch.bfloat16) * 0.05)(D)
        return {
            "x": _w((lambda *s: torch.randn(*s, dtype=torch.bfloat16) * 0.05)(B, S, D)),
            "Lambda_re": _w(Lambda_re),
            "Lambda_im": _w(Lambda_im),
            "B_re": _w(B_re),
            "B_im": _w(B_im),
            "C_re": _w(C_re),
            "C_im": _w(C_im),
            "log_dt": _w(log_dt),
            "Dskip": _w(Dskip),
        }
    _A_in = _A_setup()

    def _B_setup():
        Bsz, L, D, N = 1, 2048, 512, 128
        return {
            "u": _w((lambda *s: torch.randn(*s, dtype=torch.bfloat16) * 0.05)(Bsz, L, D)),
            "log_A_real": _w((lambda *s: torch.randn(*s, dtype=torch.bfloat16) * 3.2)(D, N) * 0.5),
            "A_imag": _w((lambda *s: torch.randn(*s, dtype=torch.bfloat16) * 0.05)(D, N) * 3.14),
            "C_real": _w((lambda *s: torch.randn(*s, dtype=torch.bfloat16) * 0.1)(D, N) / N ** 0.5),
            "C_imag": _w((lambda *s: torch.randn(*s, dtype=torch.bfloat16) * 0.1)(D, N) / N ** 0.5),
            "log_dt": _w((lambda *s: torch.randn(*s, dtype=torch.bfloat16) * 0.05)(D) * 0.5 - 4.0),
            "D_skip": _w((lambda *s: torch.randn(*s, dtype=torch.bfloat16) * 0.05)(D)),
        }
    _B_in = _B_setup()

    return {
        "A_x": _A_in["x"],
        "A_Lambda_re": _A_in["Lambda_re"],
        "A_Lambda_im": _A_in["Lambda_im"],
        "A_B_re": _A_in["B_re"],
        "A_B_im": _A_in["B_im"],
        "A_C_re": _A_in["C_re"],
        "A_C_im": _A_in["C_im"],
        "A_log_dt": _A_in["log_dt"],
        "A_Dskip": _A_in["Dskip"],
        "B_u": _B_in["u"],
        "B_log_A_real": _B_in["log_A_real"],
        "B_A_imag": _B_in["A_imag"],
        "B_C_real": _B_in["C_real"],
        "B_C_imag": _B_in["C_imag"],
        "B_log_dt": _B_in["log_dt"],
        "B_D_skip": _B_in["D_skip"],
        "gate_w": _w((lambda *s: torch.randn(*s, dtype=torch.bfloat16) * 0.05)(512) * 16.0),
    }

def reference(A_x, A_Lambda_re, A_Lambda_im, A_B_re, A_B_im, A_C_re, A_C_im, A_log_dt, A_Dskip, B_u, B_log_A_real, B_A_imag, B_C_real, B_C_imag, B_log_dt, B_D_skip, gate_w):
    def _A_ref(x, Lambda_re, Lambda_im, B_re, B_im, C_re, C_im, log_dt, Dskip):
        Bsz, L, H = x.shape
        Lam = Lambda_re + 1j * Lambda_im
        Bmat = B_re + 1j * B_im
        Cmat = C_re + 1j * C_im
        dt = torch.exp(log_dt)
        Lam_bar = torch.exp(dt * Lam)
        B_bar = ((Lam_bar - 1.0) / Lam)[:, None] * Bmat
        Bu = torch.einsum("bld,pd->blp", x + 0j, B_bar)
        h = torch.zeros_like(Bu[:, 0, :])
        hs = []
        for t in range(L):
            h = Lam_bar[None, :] * h + Bu[:, t, :]
            hs.append(h)
        hseq = torch.stack(hs, 1)
        y = 2.0 * torch.einsum("blp,dp->bld", hseq, Cmat).real + x * Dskip[None, None, :]
        return y

    def _B_ref(u, log_A_real, A_imag, C_real, C_imag, log_dt, D_skip):
        L = u.shape[1]
        dt = torch.exp(log_dt)
        A = -torch.exp(log_A_real) + 1j * A_imag
        C = (C_real + 1j * C_imag) * dt[:, None]
        pos = (lambda x, dt: x.to(dt))(torch.arange(L), log_dt.dtype)
        P = torch.exp((A * dt[:, None])[:, :, None] * pos[None, None, :])
        K = 2.0 * torch.einsum("dn,dnl->dl", C, P).real
        L2 = 2 * L
        u_t = (lambda x, *d: x.permute(*d))(u, 0, 2, 1)
        Kf = (lambda x, *a, **k: torch.fft.rfft(x.float(), *a, **k))(K, L2)
        Uf = (lambda x, *a, **k: torch.fft.rfft(x.float(), *a, **k))(u_t, L2)
        y = (lambda x, *a, **k: torch.fft.irfft(x, *a, **k).to(torch.bfloat16))(Uf * Kf[None, :, :], L2)[:, :, :L]
        y = (lambda x, *d: x.permute(*d))(y, 0, 2, 1)
        return y + u * D_skip[None, None, :]

    x = A_x
    g = _sigmoid((x * gate_w).sum(-1, keepdims=True))
    a = _A_ref(x, A_Lambda_re, A_Lambda_im, A_B_re, A_B_im, A_C_re, A_C_im, A_log_dt, A_Dskip)
    b = _B_ref(x, B_log_A_real, B_A_imag, B_C_real, B_C_imag, B_log_dt, B_D_skip)
    return g * a + (1 - g) * b
```

```asm
; @launch grid=(512,1,1) block=(256,1,1) lds=81920
.amdgcn_target "amdgcn-amd-amdhsa--gfx950"
.text
.globl gated_mix__ssm_conv_s5__ssm_conv_s4d__prompt_kernel
.p2align 8
.type gated_mix__ssm_conv_s5__ssm_conv_s4d__prompt_kernel,@function
gated_mix__ssm_conv_s5__ssm_conv_s4d__prompt_kernel:
    s_cmp_ge_u32 s2, 512
    s_cbranch_scc1 L_end
    s_load_dwordx2 s[4:5], s[0:1], 152
    s_load_dwordx2 s[8:9], s[0:1], 0
    s_load_dwordx8 s[16:23], s[0:1], 24
    s_mov_b32 s6, 33554432
    s_mov_b32 s7, 0x20000
    s_mov_b32 s10, 0x200000
    s_mov_b32 s11, 0x20000
    s_and_b32 s14, s2, 7
    s_lshr_b32 s15, s2, 3
    s_and_b32 s15, s15, 31
    v_lshrrev_b32 v2, 6, v0
    v_and_b32_e64 v1, 63, v0
    v_readfirstlane_b32 s13, v2
    s_cmp_lt_u32 s2, 256
    s_cbranch_scc1 L_roleB
    s_setprio 2
    s_load_dwordx4 s[24:27], s[0:1], 8
    s_load_dwordx4 s[28:31], s[0:1], 56
    s_load_dwordx2 s[32:33], s[0:1], 120
    s_load_dwordx2 s[36:37], s[0:1], 136
    s_mov_b32 s38, 0x400000
    s_mov_b32 s39, 0x20000
    s_lshl_b32 s44, s14, 1
    s_lshr_b32 s3, s15, 4
    s_add_u32 s44, s44, s3
    s_and_b32 s45, s15, 15
    s_lshl_b32 s46, s14, 2
    s_lshr_b32 s3, s15, 3
    s_add_u32 s46, s46, s3
    s_and_b32 s47, s15, 7
    v_and_b32 v2, 31, v1
    v_lshrrev_b32 v3, 5, v1
    v_lshrrev_b32 v16, 3, v1
    v_and_b32 v17, 7, v1
    v_lshrrev_b32 v18, 4, v1
    v_xor_b32 v19, v17, v18
    v_xor_b32 v20, 4, v19
    v_and_b32 v21, 3, v16
    v_lshl_add_u32 v21, v3, 4, v21
    v_lshlrev_b32_e64 v21, 10, v21
    v_lshl_add_u32 v4, v19, 4, v21
    v_lshl_add_u32 v5, v20, 4, v21
    v_add_u32 v5, 3072, v5
    v_add_u32 v24, 6144, v4
    v_add_u32 v25, 6144, v5
    v_lshlrev_b32_e64 v21, 10, v16
    v_lshl_add_u32 v6, v19, 4, v21
    v_lshl_add_u32 v7, v20, 4, v21
    v_add_u32 v7, 7168, v7
    s_lshl_b32 s48, s13, 12
    s_lshl_b32 s49, s44, 7
    s_lshl_b32 s3, s13, 5
    s_add_u32 s49, s49, s3
    s_lshl_b32 s49, s49, 10
    s_and_b32 s3, s13, 1
    s_lshl_b32 s3, s3, 4
    s_lshl_b32 s50, s45, 5
    s_add_u32 s50, s50, s3
    s_lshl_b32 s50, s50, 10
    s_lshl_b32 s51, s13, 11
    s_and_b32 s3, s44, 1
    s_lshl_b32 s3, s3, 2
    s_add_u32 s35, s45, s3
    s_add_u32 s35, s35, s14
    s_lshl_b32 s3, s45, 6
    v_lshl_add_u32 v16, v2, 1, s3
    s_waitcnt lgkmcnt(0)
    s_load_dword s12, s[4:5], 0x0
    s_cmp_lt_u32 s13, 2
    s_cselect_b32 s40, s16, s18
    s_cselect_b32 s41, s17, s19
    s_mov_b32 s42, 0x80000
    s_mov_b32 s43, 0x20000
    s_and_b32 s35, s35, 7
    s_lshl_b32 s35, s35, 7
    s_add_u32 s56, s49, s35
    s_add_u32 m0, s48, 0
    s_add_u32 s57, s50, s35
    buffer_load_dwordx4 v4, s[8:11], s56 offen offset:0 lds
    buffer_load_dwordx4 v5, s[8:11], s56 offen offset:1024 lds
    buffer_load_dwordx4 v24, s[8:11], s56 offen offset:2048 lds
    buffer_load_dwordx4 v25, s[8:11], s56 offen offset:3072 lds
    s_add_u32 m0, s51, 16384
    s_nop 0
    buffer_load_dwordx4 v6, s[40:43], s57 offen offset:0 lds
    buffer_load_dwordx4 v7, s[40:43], s57 offen offset:1024 lds
    global_load_ushort v17, v16, s[24:25]
    global_load_ushort v18, v16, s[26:27]
    global_load_ushort v19, v16, s[28:29]
    s_add_u32 s35, s35, 128
    s_and_b32 s35, s35, 0x380
    s_add_u32 s56, s49, s35
    s_add_u32 m0, s48, 24576
    s_add_u32 s57, s50, s35
    buffer_load_dwordx4 v4, s[8:11], s56 offen offset:0 lds
    buffer_load_dwordx4 v5, s[8:11], s56 offen offset:1024 lds
    buffer_load_dwordx4 v24, s[8:11], s56 offen offset:2048 lds
    buffer_load_dwordx4 v25, s[8:11], s56 offen offset:3072 lds
    s_add_u32 m0, s51, 40960
    s_nop 0
    buffer_load_dwordx4 v6, s[40:43], s57 offen offset:0 lds
    buffer_load_dwordx4 v7, s[40:43], s57 offen offset:1024 lds
    s_add_u32 s35, s35, 128
    s_and_b32 s35, s35, 0x380
    s_add_u32 s56, s49, s35
    s_add_u32 m0, s48, 49152
    s_add_u32 s57, s50, s35
    buffer_load_dwordx4 v4, s[8:11], s56 offen offset:0 lds
    buffer_load_dwordx4 v5, s[8:11], s56 offen offset:1024 lds
    buffer_load_dwordx4 v24, s[8:11], s56 offen offset:2048 lds
    buffer_load_dwordx4 v25, s[8:11], s56 offen offset:3072 lds
    s_add_u32 m0, s51, 65536
    s_nop 0
    buffer_load_dwordx4 v6, s[40:43], s57 offen offset:0 lds
    buffer_load_dwordx4 v7, s[40:43], s57 offen offset:1024 lds
    v_bfe_u32 v23, v2, 1, 3
    v_xor_b32 v23, v23, v3
    v_lshlrev_b32 v23, 4, v23
    v_lshl_add_u32 v12, v2, 7, v23
    v_xor_b32 v13, 32, v12
    v_xor_b32 v14, 64, v12
    v_xor_b32 v15, 0x60, v12
    v_add_u32 v8, s48, v12
    v_add_u32 v9, s48, v13
    v_add_u32 v10, s48, v14
    v_add_u32 v11, s48, v15
    v_add_u32 v12, 16384, v12
    v_add_u32 v13, 16384, v13
    v_add_u32 v14, 16384, v14
    v_add_u32 v15, 16384, v15
    s_waitcnt vmcnt(12) lgkmcnt(0)
    s_barrier
    s_mul_i32 s12, s12, 0x9E3779B1
    s_add_u32 s12, s12, 0x7F4A7C15
    ds_read_b128 v[32:35], v8 offset:0
    ds_read_b128 v[36:39], v12 offset:0
    ds_read_b128 v[40:43], v12 offset:4096
    ds_read_b128 v[44:47], v9 offset:0
    ds_read_b128 v[48:51], v13 offset:0
    ds_read_b128 v[52:55], v13 offset:4096
    s_waitcnt lgkmcnt(3)
    v_mfma_f32_32x32x16_bf16 v[96:111], v[32:35], v[36:39], 0
    ds_read_b128 v[56:59], v10 offset:0
    ds_read_b128 v[60:63], v14 offset:0
    v_lshlrev_b32 v17, 16, v17
    v_lshlrev_b32 v18, 16, v18
    v_lshlrev_b32 v19, 16, v19
    v_mfma_f32_32x32x16_bf16 v[112:127], v[32:35], v[40:43], 0
    ds_read_b128 v[64:67], v14 offset:4096
    v_mul_f32 v19, 0x3fb8aa3b, v19
    v_exp_f32 v19, v19
    s_nop 0
    v_cvt_pk_bf16_f32 v19, v19, v19
    v_lshlrev_b32 v19, 16, v19
    s_waitcnt lgkmcnt(3)
    v_mfma_f32_32x32x16_bf16 v[96:111], v[44:47], v[48:51], v[96:111]
    ds_read_b128 v[32:35], v11 offset:0
    ds_read_b128 v[36:39], v15 offset:0
    v_mul_f32 v30, v19, v17
    v_mul_f32 v31, v19, v18
    v_mul_f32 v30, 0x3fb8aa3b, v30
    v_mfma_f32_32x32x16_bf16 v[112:127], v[44:47], v[52:55], v[112:127]
    ds_read_b128 v[40:43], v15 offset:4096
    v_mul_f32 v31, 0.15915494, v31
    v_mul_f32 v83, 1.0, v30
    v_mul_f32 v84, 1.0, v31
    v_exp_f32 v83, v83
    s_waitcnt vmcnt(6) lgkmcnt(0)
    s_barrier
    v_mfma_f32_32x32x16_bf16 v[96:111], v[56:59], v[60:63], v[96:111]
    ds_read_b128 v[44:47], v8 offset:24576
    ds_read_b128 v[48:51], v12 offset:24576
    s_add_u32 s35, s35, 128
    s_and_b32 s35, s35, 0x380
    s_add_u32 s56, s49, s35
    s_add_u32 m0, s48, 0
    s_add_u32 s57, s50, s35
    buffer_load_dwordx4 v4, s[8:11], s56 offen offset:0 lds
    v_mfma_f32_32x32x16_bf16 v[112:127], v[56:59], v[64:67], v[112:127]
    ds_read_b128 v[52:55], v12 offset:28672
    buffer_load_dwordx4 v5, s[8:11], s56 offen offset:1024 lds
    s_waitcnt lgkmcnt(3)
    v_mfma_f32_32x32x16_bf16 v[96:111], v[32:35], v[36:39], v[96:111]
    ds_read_b128 v[56:59], v9 offset:24576
    ds_read_b128 v[60:63], v13 offset:24576
    buffer_load_dwordx4 v24, s[8:11], s56 offen offset:2048 lds
    v_mfma_f32_32x32x16_bf16 v[112:127], v[32:35], v[40:43], v[112:127]
    ds_read_b128 v[64:67], v13 offset:28672
    buffer_load_dwordx4 v25, s[8:11], s56 offen offset:3072 lds
    s_waitcnt lgkmcnt(3)
    v_mfma_f32_32x32x16_bf16 v[96:111], v[44:47], v[48:51], v[96:111]
    ds_read_b128 v[32:35], v10 offset:24576
    ds_read_b128 v[36:39], v14 offset:24576
    s_add_u32 m0, s51, 16384
    s_nop 0
    buffer_load_dwordx4 v6, s[40:43], s57 offen offset:0 lds
    v_mfma_f32_32x32x16_bf16 v[112:127], v[44:47], v[52:55], v[112:127]
    ds_read_b128 v[40:43], v14 offset:28672
    buffer_load_dwordx4 v7, s[40:43], s57 offen offset:1024 lds
    s_waitcnt lgkmcnt(3)
    v_mfma_f32_32x32x16_bf16 v[96:111], v[56:59], v[60:63], v[96:111]
    ds_read_b128 v[44:47], v11 offset:24576
    ds_read_b128 v[48:51], v15 offset:24576
    v_fract_f32 v84, v84
    v_cos_f32 v68, v84
    v_sin_f32 v69, v84
    v_mfma_f32_32x32x16_bf16 v[112:127], v[56:59], v[64:67], v[112:127]
    ds_read_b128 v[52:55], v15 offset:28672
    v_mul_f32 v68, v83, v68
    v_mul_f32 v69, v83, v69
    v_sub_f32_e64 v70, 0, v69
    v_mul_f32 v83, 0x41800000, v30
    s_waitcnt vmcnt(6) lgkmcnt(0)
    s_barrier
    v_mfma_f32_32x32x16_bf16 v[96:111], v[32:35], v[36:39], v[96:111]
    ds_read_b128 v[56:59], v8 offset:49152
    ds_read_b128 v[60:63], v12 offset:49152
    s_add_u32 s35, s35, 128
    s_and_b32 s35, s35, 0x380
    s_add_u32 s56, s49, s35
    s_add_u32 m0, s48, 24576
    s_add_u32 s57, s50, s35
    buffer_load_dwordx4 v4, s[8:11], s56 offen offset:0 lds
    v_mfma_f32_32x32x16_bf16 v[112:127], v[32:35], v[40:43], v[112:127]
    ds_read_b128 v[64:67], v12 offset:53248
    buffer_load_dwordx4 v5, s[8:11], s56 offen offset:1024 lds
    s_waitcnt lgkmcnt(3)
    v_mfma_f32_32x32x16_bf16 v[96:111], v[44:47], v[48:51], v[96:111]
    ds_read_b128 v[32:35], v9 offset:49152
    ds_read_b128 v[36:39], v13 offset:49152
    buffer_load_dwordx4 v24, s[8:11], s56 offen offset:2048 lds
    v_mfma_f32_32x32x16_bf16 v[112:127], v[44:47], v[52:55], v[112:127]
    ds_read_b128 v[40:43], v13 offset:53248
    buffer_load_dwordx4 v25, s[8:11], s56 offen offset:3072 lds
    s_waitcnt lgkmcnt(3)
    v_mfma_f32_32x32x16_bf16 v[96:111], v[56:59], v[60:63], v[96:111]
    ds_read_b128 v[44:47], v10 offset:49152
    ds_read_b128 v[48:51], v14 offset:49152
    s_add_u32 m0, s51, 40960
    s_nop 0
    buffer_load_dwordx4 v6, s[40:43], s57 offen offset:0 lds
    v_mfma_f32_32x32x16_bf16 v[112:127], v[56:59], v[64:67], v[112:127]
    ds_read_b128 v[52:55], v14 offset:53248
    buffer_load_dwordx4 v7, s[40:43], s57 offen offset:1024 lds
    s_waitcnt lgkmcnt(3)
    v_mfma_f32_32x32x16_bf16 v[96:111], v[32:35], v[36:39], v[96:111]
    ds_read_b128 v[56:59], v11 offset:49152
    ds_read_b128 v[60:63], v15 offset:49152
    v_mul_f32 v84, 0x41800000, v31
    v_exp_f32 v83, v83
    v_fract_f32 v84, v84
    v_mfma_f32_32x32x16_bf16 v[112:127], v[32:35], v[40:43], v[112:127]
    ds_read_b128 v[64:67], v15 offset:53248
    v_cos_f32 v71, v84
    v_sin_f32 v72, v84
    v_mul_f32 v71, v83, v71
    v_mul_f32 v72, v83, v72
    s_waitcnt vmcnt(6) lgkmcnt(0)
    s_barrier
    v_mfma_f32_32x32x16_bf16 v[96:111], v[44:47], v[48:51], v[96:111]
    ds_read_b128 v[32:35], v8 offset:0
    ds_read_b128 v[36:39], v12 offset:0
    s_add_u32 s35, s35, 128
    s_and_b32 s35, s35, 0x380
    s_add_u32 s56, s49, s35
    s_add_u32 m0, s48, 49152
    s_add_u32 s57, s50, s35
    buffer_load_dwordx4 v4, s[8:11], s56 offen offset:0 lds
    v_mfma_f32_32x32x16_bf16 v[112:127], v[44:47], v[52:55], v[112:127]
    ds_read_b128 v[40:43], v12 offset:4096
    buffer_load_dwordx4 v5, s[8:11], s56 offen offset:1024 lds
    s_waitcnt lgkmcnt(3)
    v_mfma_f32_32x32x16_bf16 v[96:111], v[56:59], v[60:63], v[96:111]
    ds_read_b128 v[44:47], v9 offset:0
    ds_read_b128 v[48:51], v13 offset:0
    buffer_load_dwordx4 v24, s[8:11], s56 offen offset:2048 lds
    v_mfma_f32_32x32x16_bf16 v[112:127], v[56:59], v[64:67], v[112:127]
    ds_read_b128 v[52:55], v13 offset:4096
    buffer_load_dwordx4 v25, s[8:11], s56 offen offset:3072 lds
    s_waitcnt lgkmcnt(3)
    v_mfma_f32_32x32x16_bf16 v[96:111], v[32:35], v[36:39], v[96:111]
    ds_read_b128 v[56:59], v10 offset:0
    ds_read_b128 v[60:63], v14 offset:0
    s_add_u32 m0, s51, 65536
    s_nop 0
    buffer_load_dwordx4 v6, s[40:43], s57 offen offset:0 lds
    v_mfma_f32_32x32x16_bf16 v[112:127], v[32:35], v[40:43], v[112:127]
    ds_read_b128 v[64:67], v14 offset:4096
    buffer_load_dwordx4 v7, s[40:43], s57 offen offset:1024 lds
    s_waitcnt lgkmcnt(3)
    v_mfma_f32_32x32x16_bf16 v[96:111], v[44:47], v[48:51], v[96:111]
    ds_read_b128 v[32:35], v11 offset:0
    ds_read_b128 v[36:39], v15 offset:0
    v_sub_f32 v73, 0, v72
    v_add_f32 v85, -1.0, v68
    v_mul_f32_e64 v86, v17, v17
    v_mfma_f32_32x32x16_bf16 v[112:127], v[44:47], v[52:55], v[112:127]
    ds_read_b128 v[40:43], v15 offset:4096
    v_fmac_f32 v86, v18, v18
    v_rcp_f32 v86, v86
    v_mul_f32 v87, v85, v17
    v_fmac_f32 v87, v69, v18
    s_waitcnt vmcnt(6) lgkmcnt(0)
    s_barrier
    v_mfma_f32_32x32x16_bf16 v[96:111], v[56:59], v[60:63], v[96:111]
    ds_read_b128 v[44:47], v8 offset:24576
    ds_read_b128 v[48:51], v12 offset:24576
    s_add_u32 s35, s35, 128
    s_and_b32 s35, s35, 0x380
    s_add_u32 s56, s49, s35
    s_add_u32 m0, s48, 0
    s_add_u32 s57, s50, s35
    buffer_load_dwordx4 v4, s[8:11], s56 offen offset:0 lds
    v_mfma_f32_32x32x16_bf16 v[112:127], v[56:59], v[64:67], v[112:127]
    ds_read_b128 v[52:55], v12 offset:28672
    buffer_load_dwordx4 v5, s[8:11], s56 offen offset:1024 lds
    s_waitcnt lgkmcnt(3)
    v_mfma_f32_32x32x16_bf16 v[96:111], v[32:35], v[36:39], v[96:111]
    ds_read_b128 v[56:59], v9 offset:24576
    ds_read_b128 v[60:63], v13 offset:24576
    buffer_load_dwordx4 v24, s[8:11], s56 offen offset:2048 lds
    v_mfma_f32_32x32x16_bf16 v[112:127], v[32:35], v[40:43], v[112:127]
    ds_read_b128 v[64:67], v13 offset:28672
    buffer_load_dwordx4 v25, s[8:11], s56 offen offset:3072 lds
    s_waitcnt lgkmcnt(3)
    v_mfma_f32_32x32x16_bf16 v[96:111], v[44:47], v[48:51], v[96:111]
    ds_read_b128 v[32:35], v10 offset:24576
    ds_read_b128 v[36:39], v14 offset:24576
    s_add_u32 m0, s51, 16384
    s_nop 0
    buffer_load_dwordx4 v6, s[40:43], s57 offen offset:0 lds
    v_mfma_f32_32x32x16_bf16 v[112:127], v[44:47], v[52:55], v[112:127]
    ds_read_b128 v[40:43], v14 offset:28672
    buffer_load_dwordx4 v7, s[40:43], s57 offen offset:1024 lds
    s_waitcnt lgkmcnt(3)
    v_mfma_f32_32x32x16_bf16 v[96:111], v[56:59], v[60:63], v[96:111]
    ds_read_b128 v[44:47], v11 offset:24576
    ds_read_b128 v[48:51], v15 offset:24576
    v_mul_f32 v88, v69, v17
    v_fma_f32 v88, -v85, v18, v88
    v_add_f32_e64 v86, v86, v86
    v_mfma_f32_32x32x16_bf16 v[112:127], v[56:59], v[64:67], v[112:127]
    ds_read_b128 v[52:55], v15 offset:28672
    v_mul_f32 v74, v87, v86
    v_mul_f32 v75, v88, v86
    s_lshl_b32 s58, s13, 1
    v_add_u32 v82, s58, v3
    s_waitcnt vmcnt(6) lgkmcnt(0)
    s_barrier
    v_mfma_f32_32x32x16_bf16 v[96:111], v[32:35], v[36:39], v[96:111]
    ds_read_b128 v[56:59], v8 offset:49152
    ds_read_b128 v[60:63], v12 offset:49152
    s_add_u32 s35, s35, 128
    s_and_b32 s35, s35, 0x380
    s_add_u32 s56, s49, s35
    s_add_u32 m0, s48, 24576
    s_add_u32 s57, s50, s35
    buffer_load_dwordx4 v4, s[8:11], s56 offen offset:0 lds
    v_mfma_f32_32x32x16_bf16 v[112:127], v[32:35], v[40:43], v[112:127]
    ds_read_b128 v[64:67], v12 offset:53248
    buffer_load_dwordx4 v5, s[8:11], s56 offen offset:1024 lds
    s_waitcnt lgkmcnt(3)
    v_mfma_f32_32x32x16_bf16 v[96:111], v[44:47], v[48:51], v[96:111]
    ds_read_b128 v[32:35], v9 offset:49152
    ds_read_b128 v[36:39], v13 offset:49152
    buffer_load_dwordx4 v24, s[8:11], s56 offen offset:2048 lds
    v_mfma_f32_32x32x16_bf16 v[112:127], v[44:47], v[52:55], v[112:127]
    ds_read_b128 v[40:43], v13 offset:53248
    buffer_load_dwordx4 v25, s[8:11], s56 offen offset:3072 lds
    s_waitcnt lgkmcnt(3)
    v_mfma_f32_32x32x16_bf16 v[96:111], v[56:59], v[60:63], v[96:111]
    ds_read_b128 v[44:47], v10 offset:49152
    ds_read_b128 v[48:51], v14 offset:49152
    s_add_u32 m0, s51, 40960
    s_nop 0
    buffer_load_dwordx4 v6, s[40:43], s57 offen offset:0 lds
    v_mfma_f32_32x32x16_bf16 v[112:127], v[56:59], v[64:67], v[112:127]
    ds_read_b128 v[52:55], v14 offset:53248
    buffer_load_dwordx4 v7, s[40:43], s57 offen offset:1024 lds
    s_waitcnt lgkmcnt(3)
    v_mfma_f32_32x32x16_bf16 v[96:111], v[32:35], v[36:39], v[96:111]
    ds_read_b128 v[56:59], v11 offset:49152
    ds_read_b128 v[60:63], v15 offset:49152
    v_cvt_f32_u32_e64 v85, v82
    v_mul_f32 v85, 0x41800000, v85
    v_mul_f32_e64 v83, v85, v30
    v_mfma_f32_32x32x16_bf16 v[112:127], v[32:35], v[40:43], v[112:127]
    ds_read_b128 v[64:67], v15 offset:53248
    v_mul_f32 v84, v85, v31
    v_exp_f32 v83, v83
    v_fract_f32 v84, v84
    v_cos_f32 v80, v84
    s_waitcnt vmcnt(6) lgkmcnt(0)
    s_barrier
    v_mfma_f32_32x32x16_bf16 v[96:111], v[44:47], v[48:51], v[96:111]
    ds_read_b128 v[32:35], v8 offset:0
    ds_read_b128 v[36:39], v12 offset:0
    v_sin_f32 v81, v84
    v_mul_f32 v80, v83, v80
    v_mul_f32_e64 v81, v83, v81
    v_mfma_f32_32x32x16_bf16 v[112:127], v[44:47], v[52:55], v[112:127]
    ds_read_b128 v[40:43], v12 offset:4096
    s_sub_u32 s58, s44, 1
    v_sub_u32 v85, s58, v82
    v_add_u32_e64 v86, -8, v85
    v_cmp_le_i32 s[52:53], 0, v85
    s_waitcnt lgkmcnt(3)
    v_mfma_f32_32x32x16_bf16 v[96:111], v[56:59], v[60:63], v[96:111]
    ds_read_b128 v[44:47], v9 offset:0
    ds_read_b128 v[48:51], v13 offset:0
    v_cmp_le_i32 s[54:55], 0, v86
    v_max_i32 v85, 0, v85
    v_max_i32_e64 v86, 0, v86
    v_mfma_f32_32x32x16_bf16 v[112:127], v[56:59], v[64:67], v[112:127]
    ds_read_b128 v[52:55], v13 offset:4096
    v_cvt_f32_i32 v85, v85
    v_cvt_f32_i32 v86, v86
    v_mul_f32 v85, 0x43000000, v85
    v_mul_f32 v86, 0x43000000, v86
    s_waitcnt lgkmcnt(3)
    v_mfma_f32_32x32x16_bf16 v[96:111], v[32:35], v[36:39], v[96:111]
    ds_read_b128 v[56:59], v10 offset:0
    ds_read_b128 v[60:63], v14 offset:0
    v_mul_f32 v83, v85, v30
    v_mul_f32 v84, v85, v31
    v_exp_f32 v83, v83
    v_mfma_f32_32x32x16_bf16 v[112:127], v[32:35], v[40:43], v[112:127]
    ds_read_b128 v[64:67], v14 offset:4096
    v_fract_f32 v84, v84
    v_cos_f32 v76, v84
    v_sin_f32 v77, v84
    v_mul_f32_e64 v76, v83, v76
    s_waitcnt lgkmcnt(3)
    v_mfma_f32_32x32x16_bf16 v[96:111], v[44:47], v[48:51], v[96:111]
    ds_read_b128 v[32:35], v11 offset:0
    ds_read_b128 v[36:39], v15 offset:0
    v_mul_f32 v77, v83, v77
    v_mul_f32 v83, v86, v30
    v_mul_f32_e64 v84, v86, v31
    v_mfma_f32_32x32x16_bf16 v[112:127], v[44:47], v[52:55], v[112:127]
    ds_read_b128 v[40:43], v15 offset:4096
    v_exp_f32 v83, v83
    v_fract_f32 v84, v84
    v_cos_f32 v78, v84
    v_sin_f32 v79, v84
    s_waitcnt vmcnt(0) lgkmcnt(0)
    s_barrier
    v_mfma_f32_32x32x16_bf16 v[96:111], v[56:59], v[60:63], v[96:111]
    ds_read_b128 v[44:47], v8 offset:24576
    ds_read_b128 v[48:51], v12 offset:24576
    v_mul_f32 v78, v83, v78
    v_mul_f32 v79, v83, v79
    v_cndmask_b32 v76, 0, v76, s[52:53]
    v_mfma_f32_32x32x16_bf16 v[112:127], v[56:59], v[64:67], v[112:127]
    ds_read_b128 v[52:55], v12 offset:28672
    v_cndmask_b32 v77, 0, v77, s[52:53]
    v_cndmask_b32 v78, 0, v78, s[54:55]
    v_cndmask_b32 v79, 0, v79, s[54:55]
    s_waitcnt lgkmcnt(3)
    v_mfma_f32_32x32x16_bf16 v[96:111], v[32:35], v[36:39], v[96:111]
    ds_read_b128 v[56:59], v9 offset:24576
    ds_read_b128 v[60:63], v13 offset:24576
    v_mfma_f32_32x32x16_bf16 v[112:127], v[32:35], v[40:43], v[112:127]
    ds_read_b128 v[64:67], v13 offset:28672
    s_waitcnt lgkmcnt(3)
    v_mfma_f32_32x32x16_bf16 v[96:111], v[44:47], v[48:51], v[96:111]
    ds_read_b128 v[32:35], v10 offset:24576
    ds_read_b128 v[36:39], v14 offset:24576
    v_mfma_f32_32x32x16_bf16 v[112:127], v[44:47], v[52:55], v[112:127]
    ds_read_b128 v[40:43], v14 offset:28672
    s_waitcnt lgkmcnt(3)
    v_mfma_f32_32x32x16_bf16 v[96:111], v[56:59], v[60:63], v[96:111]
    ds_read_b128 v[44:47], v11 offset:24576
    ds_read_b128 v[48:51], v15 offset:24576
    v_mfma_f32_32x32x16_bf16 v[112:127], v[56:59], v[64:67], v[112:127]
    ds_read_b128 v[52:55], v15 offset:28672
    s_waitcnt lgkmcnt(3)
    v_mfma_f32_32x32x16_bf16 v[96:111], v[32:35], v[36:39], v[96:111]
    v_mfma_f32_32x32x16_bf16 v[112:127], v[32:35], v[40:43], v[112:127]
    s_waitcnt lgkmcnt(0)
    v_mfma_f32_32x32x16_bf16 v[96:111], v[44:47], v[48:51], v[96:111]
    v_mfma_f32_32x32x16_bf16 v[112:127], v[44:47], v[52:55], v[112:127]
    s_setprio 2
    s_nop 9
    v_fmac_f32 v97, v68, v96
    v_fmac_f32 v113, v68, v112
    v_fmac_f32 v97, v70, v112
    v_fmac_f32 v113, v69, v96
    v_fmac_f32 v98, v68, v97
    v_fmac_f32 v114, v68, v113
    v_fmac_f32 v98, v70, v113
    v_fmac_f32 v114, v69, v97
    v_fmac_f32 v99, v68, v98
    v_fmac_f32 v115, v68, v114
    v_fmac_f32 v99, v70, v114
    v_fmac_f32 v115, v69, v98
    v_fmac_f32 v100, v68, v99
    v_fmac_f32 v116, v68, v115
    v_fmac_f32 v100, v70, v115
    v_fmac_f32 v116, v69, v99
    v_fmac_f32 v101, v68, v100
    v_fmac_f32 v117, v68, v116
    v_fmac_f32 v101, v70, v116
    v_fmac_f32 v117, v69, v100
    v_fmac_f32 v102, v68, v101
    v_fmac_f32 v118, v68, v117
    v_fmac_f32 v102, v70, v117
    v_fmac_f32 v118, v69, v101
    v_fmac_f32 v103, v68, v102
    v_fmac_f32 v119, v68, v118
    v_fmac_f32 v103, v70, v118
    v_fmac_f32 v119, v69, v102
    v_fmac_f32 v104, v68, v103
    v_fmac_f32 v120, v68, v119
    v_fmac_f32 v104, v70, v119
    v_fmac_f32 v120, v69, v103
    v_fmac_f32 v105, v68, v104
    v_fmac_f32 v121, v68, v120
    v_fmac_f32 v105, v70, v120
    v_fmac_f32 v121, v69, v104
    v_fmac_f32 v106, v68, v105
    v_fmac_f32 v122, v68, v121
    v_fmac_f32 v106, v70, v121
    v_fmac_f32 v122, v69, v105
    v_fmac_f32 v107, v68, v106
    v_fmac_f32 v123, v68, v122
    v_fmac_f32 v107, v70, v122
    v_fmac_f32 v123, v69, v106
    v_fmac_f32 v108, v68, v107
    v_fmac_f32 v124, v68, v123
    v_fmac_f32 v108, v70, v123
    v_fmac_f32 v124, v69, v107
    v_fmac_f32 v109, v68, v108
    v_fmac_f32 v125, v68, v124
    v_fmac_f32 v109, v70, v124
    v_fmac_f32 v125, v69, v108
    v_fmac_f32 v110, v68, v109
    v_fmac_f32 v126, v68, v125
    v_fmac_f32 v110, v70, v125
    v_fmac_f32 v126, v69, v109
    v_fmac_f32 v111, v68, v110
    v_fmac_f32 v127, v68, v126
    v_fmac_f32 v111, v70, v126
    v_fmac_f32 v127, v69, v110
    v_lshlrev_b32 v4, 3, v2
    v_lshl_add_u32 v5, v82, 8, v4
    ds_write2_b32 v5, v111, v127 offset0:0 offset1:1
    s_lshl_b32 s3, s45, 4
    s_add_u32 s3, s3, s44
    s_lshl_b32 s56, s3, 9
    s_add_u32 s56, s56, 196608
    s_lshl_b32 s57, s45, 13
    s_add_u32 s57, s57, 196608
    v_lshlrev_b32 v6, 4, v2
    v_mov_b32 v49, s12
    v_mov_b32_e64 v51, s12
    s_waitcnt lgkmcnt(0)
    s_barrier
    ds_read_b64 v[32:33], v4 offset:0
    ds_read_b64 v[34:35], v4 offset:256
    ds_read_b64 v[36:37], v4 offset:512
    ds_read_b64 v[38:39], v4 offset:768
    ds_read_b64 v[40:41], v4 offset:1024
    ds_read_b64 v[42:43], v4 offset:1280
    ds_read_b64 v[44:45], v4 offset:1536
    ds_read_b64 v[46:47], v4 offset:1792
    s_waitcnt lgkmcnt(6)
    v_fmac_f32 v34, v71, v32
    v_fmac_f32 v35, v71, v33
    v_fmac_f32 v34, v73, v33
    v_fmac_f32 v35, v72, v32
    s_waitcnt lgkmcnt(5)
    v_fmac_f32 v36, v71, v34
    v_fmac_f32 v37, v71, v35
    v_fmac_f32 v36, v73, v35
    v_fmac_f32 v37, v72, v34
    s_waitcnt lgkmcnt(4)
    v_fmac_f32 v38, v71, v36
    v_fmac_f32 v39, v71, v37
    v_fmac_f32 v38, v73, v37
    v_fmac_f32 v39, v72, v36
    s_waitcnt lgkmcnt(3)
    v_fmac_f32 v40, v71, v38
    v_fmac_f32 v41, v71, v39
    v_fmac_f32 v40, v73, v39
    v_fmac_f32 v41, v72, v38
    s_waitcnt lgkmcnt(2)
    v_fmac_f32 v42, v71, v40
    v_fmac_f32 v43, v71, v41
    v_fmac_f32 v42, v73, v41
    v_fmac_f32 v43, v72, v40
    s_waitcnt lgkmcnt(1)
    v_fmac_f32 v44, v71, v42
    v_fmac_f32 v45, v71, v43
    v_fmac_f32 v44, v73, v43
    v_fmac_f32 v45, v72, v42
    s_waitcnt lgkmcnt(0)
    v_fmac_f32 v46, v71, v44
    v_fmac_f32 v47, v71, v45
    v_fmac_f32 v46, v73, v45
    v_fmac_f32 v47, v72, v44
    v_mov_b32 v48, v46
    v_mov_b32 v50, v47
    s_cmp_eq_u32 s13, 0
    s_cbranch_scc0 L_A_nopub
    s_mov_b32 exec_hi, 0
    buffer_store_dwordx4 v[48:51], v6, s[4:7], s56 offen sc1
    s_mov_b32 exec_hi, -1
L_A_nopub:
    v_and_b32 v29, 7, v1
    s_lshl_b32 s3, s13, 3
    v_add_u32 v29, s3, v29
    v_lshlrev_b32 v29, 7, v29
    s_lshl_b32 s3, s47, 12
    s_add_u32 s59, s3, 458752
    buffer_load_dword v30, v29, s[4:7], s59 offen sc1
    v_mov_b32 v8, 0
    v_mov_b32 v9, 0
    v_cmp_eq_u32 vcc, 1, v82
    s_nop 1
    v_cndmask_b32 v8, v8, v32, vcc
    v_cndmask_b32 v9, v9, v33, vcc
    v_cmp_eq_u32 vcc, 2, v82
    s_nop 1
    v_cndmask_b32 v8, v8, v34, vcc
    v_cndmask_b32 v9, v9, v35, vcc
    v_cmp_eq_u32 vcc, 3, v82
    s_nop 1
    v_cndmask_b32 v8, v8, v36, vcc
    v_cndmask_b32 v9, v9, v37, vcc
    v_cmp_eq_u32 vcc, 4, v82
    s_nop 1
    v_cndmask_b32 v8, v8, v38, vcc
    v_cndmask_b32 v9, v9, v39, vcc
    v_cmp_eq_u32 vcc, 5, v82
    s_nop 1
    v_cndmask_b32 v8, v8, v40, vcc
    v_cndmask_b32 v9, v9, v41, vcc
    v_cmp_eq_u32 vcc, 6, v82
    s_nop 1
    v_cndmask_b32 v8, v8, v42, vcc
    v_cndmask_b32 v9, v9, v43, vcc
    v_cmp_eq_u32 vcc, 7, v82
    s_nop 1
    v_cndmask_b32 v8, v8, v44, vcc
    v_cndmask_b32 v9, v9, v45, vcc
    v_mov_b32 v10, v68
    v_mov_b32 v11, v69
    v_mov_b32 v12, v70
    v_mov_b32 v13, v74
    v_mov_b32 v14, v75
    v_sub_f32 v15, 0, v74
    v_sub_f32 v16, 0, v75
    v_mov_b32 v17, v76
    v_mov_b32 v18, v77
    v_mov_b32 v19, v78
    v_mov_b32 v20, v79
    v_mov_b32 v21, v80
    v_mov_b32 v22, v81
    v_mov_b32 v23, v82
    v_mul_f32 v64, v13, v96
    v_mul_f32 v80, v15, v112
    v_fmac_f32 v64, v16, v112
    v_fmac_f32 v80, v16, v96
    v_mul_f32 v65, v13, v97
    v_mul_f32 v81, v15, v113
    v_fmac_f32 v65, v16, v113
    v_fmac_f32 v81, v16, v97
    v_mul_f32 v66, v13, v98
    v_mul_f32 v82, v15, v114
    v_fmac_f32 v66, v16, v114
    v_fmac_f32 v82, v16, v98
    v_mul_f32 v67, v13, v99
    v_mul_f32 v83, v15, v115
    v_fmac_f32 v67, v16, v115
    v_fmac_f32 v83, v16, v99
    v_mul_f32 v68, v13, v100
    v_mul_f32 v84, v15, v116
    v_fmac_f32 v68, v16, v116
    v_fmac_f32 v84, v16, v100
    v_mul_f32 v69, v13, v101
    v_mul_f32 v85, v15, v117
    v_fmac_f32 v69, v16, v117
    v_fmac_f32 v85, v16, v101
    v_mul_f32 v70, v13, v102
    v_mul_f32 v86, v15, v118
    v_fmac_f32 v70, v16, v118
    v_fmac_f32 v86, v16, v102
    v_mul_f32 v71, v13, v103
    v_mul_f32 v87, v15, v119
    v_fmac_f32 v71, v16, v119
    v_fmac_f32 v87, v16, v103
    v_mul_f32 v72, v13, v104
    v_mul_f32 v88, v15, v120
    v_fmac_f32 v72, v16, v120
    v_fmac_f32 v88, v16, v104
    v_mul_f32 v73, v13, v105
    v_mul_f32 v89, v15, v121
    v_fmac_f32 v73, v16, v121
    v_fmac_f32 v89, v16, v105
    v_mul_f32 v74, v13, v106
    v_mul_f32 v90, v15, v122
    v_fmac_f32 v74, v16, v122
    v_fmac_f32 v90, v16, v106
    v_mul_f32 v75, v13, v107
    v_mul_f32 v91, v15, v123
    v_fmac_f32 v75, v16, v123
    v_fmac_f32 v91, v16, v107
    v_mul_f32 v76, v13, v108
    v_mul_f32 v92, v15, v124
    v_fmac_f32 v76, v16, v124
    v_fmac_f32 v92, v16, v108
    v_mul_f32 v77, v13, v109
    v_mul_f32 v93, v15, v125
    v_fmac_f32 v77, v16, v125
    v_fmac_f32 v93, v16, v109
    v_mul_f32 v78, v13, v110
    v_mul_f32 v94, v15, v126
    v_fmac_f32 v78, v16, v126
    v_fmac_f32 v94, v16, v110
    v_mul_f32 v79, v13, v111
    v_mul_f32 v95, v15, v127
    v_fmac_f32 v79, v16, v127
    v_fmac_f32 v95, v16, v111
    v_mul_f32 v32, v13, v10
    v_mul_f32 v33, v13, v11
    v_fmac_f32 v32, v14, v12
    v_fmac_f32 v33, v14, v10
    v_mul_f32 v34, v32, v10
    v_mul_f32 v35, v32, v11
    v_fmac_f32 v34, v33, v12
    v_fmac_f32 v35, v33, v10
    v_mul_f32 v36, v34, v10
    v_mul_f32 v37, v34, v11
    v_fmac_f32 v36, v35, v12
    v_fmac_f32 v37, v35, v10
    v_mul_f32 v38, v36, v10
    v_mul_f32 v39, v36, v11
    v_fmac_f32 v38, v37, v12
    v_fmac_f32 v39, v37, v10
    v_mul_f32 v40, v38, v10
    v_mul_f32 v41, v38, v11
    v_fmac_f32 v40, v39, v12
    v_fmac_f32 v41, v39, v10
    v_mul_f32 v42, v40, v10
    v_mul_f32 v43, v40, v11
    v_fmac_f32 v42, v41, v12
    v_fmac_f32 v43, v41, v10
    v_mul_f32 v44, v42, v10
    v_mul_f32 v45, v42, v11
    v_fmac_f32 v44, v43, v12
    v_fmac_f32 v45, v43, v10
    v_mul_f32 v46, v44, v10
    v_mul_f32 v47, v44, v11
    v_fmac_f32 v46, v45, v12
    v_fmac_f32 v47, v45, v10
    v_mul_f32 v48, v46, v10
    v_mul_f32 v49, v46, v11
    v_fmac_f32 v48, v47, v12
    v_fmac_f32 v49, v47, v10
    v_mul_f32 v50, v48, v10
    v_mul_f32 v51, v48, v11
    v_fmac_f32 v50, v49, v12
    v_fmac_f32 v51, v49, v10
    v_mul_f32 v52, v50, v10
    v_mul_f32 v53, v50, v11
    v_fmac_f32 v52, v51, v12
    v_fmac_f32 v53, v51, v10
    v_mul_f32 v54, v52, v10
    v_mul_f32 v55, v52, v11
    v_fmac_f32 v54, v53, v12
    v_fmac_f32 v55, v53, v10
    v_mul_f32 v56, v54, v10
    v_mul_f32 v57, v54, v11
    v_fmac_f32 v56, v55, v12
    v_fmac_f32 v57, v55, v10
    v_mul_f32 v58, v56, v10
    v_mul_f32 v59, v56, v11
    v_fmac_f32 v58, v57, v12
    v_fmac_f32 v59, v57, v10
    v_mul_f32 v60, v58, v10
    v_mul_f32 v61, v58, v11
    v_fmac_f32 v60, v59, v12
    v_fmac_f32 v61, v59, v10
    v_mul_f32 v62, v60, v10
    v_mul_f32 v63, v60, v11
    v_fmac_f32 v62, v61, v12
    v_fmac_f32 v63, v61, v10
    s_lshr_b32 s63, s13, 1
    s_and_b32 s34, s13, 1
    s_lshl_b32 s3, s47, 1
    s_add_u32 s3, s3, s34
    s_lshl_b32 s60, s3, 6
    s_xor_b32 s3, s3, 1
    s_lshl_b32 s61, s3, 6
    s_lshl_b32 s3, s13, 4
    s_add_u32 s60, s60, s3
    s_add_u32 s61, s61, s3
    s_lshl_b32 s60, s60, 10
    s_lshl_b32 s61, s61, 10
    s_add_u32 s60, s60, 3145728
    s_add_u32 s61, s61, 3145728
    s_and_b32 s3, s46, 3
    s_lshl_b32 s3, s3, 1
    s_add_u32 s35, s47, s3
    s_and_b32 s35, s35, 7
    s_lshl_b32 s35, s35, 1
    v_lshlrev_b32 v7, 4, v1
    v_mov_b32 v96, 0
    v_mov_b32 v98, 0
    v_mov_b32 v100, 0
    v_mov_b32 v102, 0
    v_lshl_add_u32 v24, v23, 9, v6
    s_mov_b32 s99, 0
    s_cmp_eq_u64 s[52:53], 0
    s_cbranch_scc1 L_A_lbdone
L_A_lb:
    s_mov_b64 exec, s[52:53]
    buffer_load_dwordx4 v[96:99], v24, s[4:7], s57 offen sc1
    s_cmp_eq_u64 s[54:55], 0
    s_cbranch_scc1 L_A_lb1b
    s_mov_b64 exec, s[54:55]
    s_add_u32 s3, s57, 4096
    buffer_load_dwordx4 v[100:103], v24, s[4:7], s3 offen sc1
L_A_lb1b:
    s_mov_b64 exec, -1
    s_waitcnt vmcnt(0)
    v_cmp_ne_u32 s[16:17], s12, v97
    v_cmp_ne_u32_e64 vcc, s12, v99
    s_nop 0
    s_or_b64 s[16:17], s[16:17], vcc
    s_and_b64 s[16:17], s[16:17], s[52:53]
    v_cmp_ne_u32 s[18:19], s12, v101
    v_cmp_ne_u32 vcc, s12, v103
    s_nop 0
    s_or_b64 s[18:19], s[18:19], vcc
    s_and_b64 s[18:19], s[18:19], s[54:55]
    s_or_b64 s[16:17], s[16:17], s[18:19]
    s_cbranch_scc0 L_A_lbdone
    s_sleep 3
    s_add_u32 s99, s99, 1
    s_cmp_lt_u32 s99, 20000
    s_cbranch_scc1 L_A_lb
L_A_lbdone:
    s_waitcnt vmcnt(0)
    v_cmp_ne_u32 s[22:23], s12, v30
    s_nop 0
    s_cmp_eq_u64 s[22:23], 0
    s_branch L_A_nowarm
    v_lshrrev_b32 v104, 3, v1
    s_lshl_b32 s3, s13, 3
    v_add_u32 v104, s3, v104
    v_and_b32 v104, 15, v104
    v_lshlrev_b32 v104, 2, v104
    s_and_b32 s3, s46, 3
    v_add_u32 v104, s3, v104
    v_lshlrev_b32 v104, 10, v104
    v_and_b32 v105, 7, v1
    v_lshl_add_u32 v104, v105, 7, v104
    s_lshl_b32 s3, s47, 1
    s_lshr_b32 s58, s13, 1
    s_add_u32 s3, s3, s58
    s_lshl_b32 s3, s3, 16
    s_add_u32 s3, s3, 3145728
    buffer_load_dword a127, v104, s[4:7], s3 offen sc1
L_A_nowarm:
    s_cmp_eq_u64 s[22:23], 0
    s_cbranch_scc1 L_A_cfok0
    s_lshl_b32 s3, s47, 12
    s_add_u32 s59, s3, 458752
    s_mov_b32 s99, 0
L_poll_1:
    buffer_load_dword v30, v29, s[4:7], s59 offen sc1
    s_waitcnt vmcnt(0)
    v_cmp_ne_u32_e64 vcc, s12, v30
    s_cbranch_vccz L_polld_2
    s_sleep 3
    s_add_u32 s99, s99, 1
    s_cmp_lt_u32 s99, 20000
    s_cbranch_scc1 L_poll_1
L_polld_2:
    s_mov_b64 s[22:23], 0
L_A_cfok0:
    v_mul_f32 v104, v17, v96
    v_mul_f32 v105, v17, v98
    v_fma_f32 v104, -v18, v98, v104
    v_fmac_f32 v105, v18, v96
    v_fmac_f32 v104, v19, v100
    v_fmac_f32_e64 v105, v19, v102
    v_fma_f32 v104, -v20, v102, v104
    v_fmac_f32_e64 v105, v20, v100
    v_add_u32 v25, 2048, v5
    ds_write2_b32 v25, v104, v105 offset0:0 offset1:1
    v_lshrrev_b32_e64 v26, 2, v2
    v_mul_u32_u24 v26, 528, v26
    v_and_b32_e64 v27, 3, v2
    v_lshl_add_u32 v26, v27, 2, v26
    v_lshl_add_u32 v26, v3, 6, v26
    s_mul_i32 s3, s13, 4224
    s_add_u32 s3, s3, 4096
    v_add_u32_e64 v26, s3, v26
    v_mul_u32_u24 v27, 528, v3
    v_lshl_add_u32 v27, v2, 4, v27
    v_add_u32_e64 v27, s3, v27
    s_lshl_b32 s58, s44, 2
    s_add_u32 s58, s58, s13
    s_lshl_b32 s58, s58, 6
    s_lshl_b32 s3, s45, 2
    s_add_u32 s58, s58, s3
    s_lshl_b32 s58, s58, 10
    s_add_u32 s20, s58, 4194304
    s_waitcnt lgkmcnt(0)
    s_barrier
    ds_read_b64 v[96:97], v4 offset:2048
    ds_read_b64 v[98:99], v4 offset:2304
    ds_read_b64 v[100:101], v4 offset:2560
    ds_read_b64 v[102:103], v4 offset:2816
    ds_read_b64 v[104:105], v4 offset:3072
    ds_read_b64 v[106:107], v4 offset:3328
    ds_read_b64 v[108:109], v4 offset:3584
    ds_read_b64 v[110:111], v4 offset:3840
    s_waitcnt lgkmcnt(0)
    v_add_f32 v96, v96, v104
    v_add_f32 v97, v97, v105
    v_add_f32 v98, v98, v106
    v_add_f32 v99, v99, v107
    v_add_f32 v100, v100, v108
    v_add_f32 v101, v101, v109
    v_add_f32 v102, v102, v110
    v_add_f32 v103, v103, v111
    v_add_f32 v96, v96, v100
    v_add_f32 v97, v97, v101
    v_add_f32 v98, v98, v102
    v_add_f32 v99, v99, v103
    v_add_f32 v96, v96, v98
    v_add_f32 v97, v97, v99
    v_fmac_f32 v8, v21, v96
    v_fmac_f32_e64 v9, v21, v97
    v_fma_f32 v8, -v22, v97, v8
    v_fmac_f32 v9, v22, v96
    v_sub_f32 v10, 0, v8
    v_sub_f32 v11, 0, v9
    s_add_u32 s3, s35, 0
    s_and_b32 s3, s3, 15
    s_lshl_b32 s3, s3, 10
    s_add_u32 s58, s60, s3
    s_add_u32 s59, s61, s3
    buffer_load_dwordx4 a[0:3], v7, s[4:7], s58 offen offset:0 sc1
    buffer_load_dwordx4 a[4:7], v7, s[4:7], s59 offen offset:0 sc1
    buffer_load_dwordx4 a[8:11], v7, s[4:7], s58 offen offset:1024 sc1
    buffer_load_dwordx4 a[12:15], v7, s[4:7], s59 offen offset:1024 sc1
    v_fmac_f32 v64, v32, v8
    v_fmac_f32 v80, v32, v11
    v_fmac_f32 v64, v33, v11
    v_fmac_f32 v80, v33, v10
    v_cvt_pk_bf16_f32 v96, v64, v80
    ds_write_b32 v26, v96 offset:0
    s_add_u32 s3, s35, 2
    s_and_b32 s3, s3, 15
    s_lshl_b32 s3, s3, 10
    s_add_u32 s58, s60, s3
    s_add_u32 s59, s61, s3
    buffer_load_dwordx4 a[16:19], v7, s[4:7], s58 offen offset:0 sc1
    v_fmac_f32 v65, v34, v8
    v_fmac_f32 v81, v34, v11
    v_fmac_f32 v65, v35, v11
    v_fmac_f32_e64 v81, v35, v10
    v_cvt_pk_bf16_f32 v97, v65, v81
    ds_write_b32 v26, v97 offset:128
    buffer_load_dwordx4 a[20:23], v7, s[4:7], s59 offen offset:0 sc1
    v_fmac_f32 v66, v36, v8
    v_fmac_f32 v82, v36, v11
    v_fmac_f32 v66, v37, v11
    v_fmac_f32 v82, v37, v10
    v_cvt_pk_bf16_f32 v98, v66, v82
    ds_write_b32 v26, v98 offset:256
    buffer_load_dwordx4 a[24:27], v7, s[4:7], s58 offen offset:1024 sc1
    v_fmac_f32 v67, v38, v8
    v_fmac_f32 v83, v38, v11
    v_fmac_f32 v67, v39, v11
    v_fmac_f32 v83, v39, v10
    v_cvt_pk_bf16_f32 v99, v67, v83
    ds_write_b32 v26, v99 offset:384
    buffer_load_dwordx4 a[28:31], v7, s[4:7], s59 offen offset:1024 sc1
    v_fmac_f32 v68, v40, v8
    v_fmac_f32 v84, v40, v11
    v_fmac_f32 v68, v41, v11
    v_fmac_f32 v84, v41, v10
    v_cvt_pk_bf16_f32 v100, v68, v84
    ds_write_b32 v26, v100 offset:16
    s_add_u32 s3, s35, 4
    s_and_b32 s3, s3, 15
    s_lshl_b32 s3, s3, 10
    s_add_u32 s58, s60, s3
    s_add_u32 s59, s61, s3
    buffer_load_dwordx4 a[32:35], v7, s[4:7], s58 offen offset:0 sc1
    v_fmac_f32 v69, v42, v8
    v_fmac_f32 v85, v42, v11
    v_fmac_f32 v69, v43, v11
    v_fmac_f32_e64 v85, v43, v10
    v_cvt_pk_bf16_f32 v101, v69, v85
    ds_write_b32 v26, v101 offset:144
    buffer_load_dwordx4 a[36:39], v7, s[4:7], s59 offen offset:0 sc1
    v_fmac_f32 v70, v44, v8
    v_fmac_f32 v86, v44, v11
    v_fmac_f32 v70, v45, v11
    v_fmac_f32 v86, v45, v10
    v_cvt_pk_bf16_f32 v102, v70, v86
    ds_write_b32 v26, v102 offset:272
    buffer_load_dwordx4 a[40:43], v7, s[4:7], s58 offen offset:1024 sc1
    v_fmac_f32 v71, v46, v8
    v_fmac_f32 v87, v46, v11
    v_fmac_f32 v71, v47, v11
    v_fmac_f32 v87, v47, v10
    v_cvt_pk_bf16_f32 v103, v71, v87
    ds_write_b32 v26, v103 offset:400
    buffer_load_dwordx4 a[44:47], v7, s[4:7], s59 offen offset:1024 sc1
    v_fmac_f32 v72, v48, v8
    v_fmac_f32 v88, v48, v11
    v_fmac_f32 v72, v49, v11
    v_fmac_f32 v88, v49, v10
    v_cvt_pk_bf16_f32 v104, v72, v88
    ds_write_b32 v26, v104 offset:32
    s_add_u32 s3, s35, 6
    s_and_b32 s3, s3, 15
    s_lshl_b32 s3, s3, 10
    s_add_u32 s58, s60, s3
    s_add_u32 s59, s61, s3
    buffer_load_dwordx4 a[48:51], v7, s[4:7], s58 offen offset:0 sc1
    v_fmac_f32 v73, v50, v8
    v_fmac_f32 v89, v50, v11
    v_fmac_f32 v73, v51, v11
    v_fmac_f32_e64 v89, v51, v10
    v_cvt_pk_bf16_f32 v105, v73, v89
    ds_write_b32 v26, v105 offset:160
    buffer_load_dwordx4 a[52:55], v7, s[4:7], s59 offen offset:0 sc1
    v_fmac_f32 v74, v52, v8
    v_fmac_f32 v90, v52, v11
    v_fmac_f32 v74, v53, v11
    v_fmac_f32 v90, v53, v10
    v_cvt_pk_bf16_f32 v106, v74, v90
    ds_write_b32 v26, v106 offset:288
    buffer_load_dwordx4 a[56:59], v7, s[4:7], s58 offen offset:1024 sc1
    v_fmac_f32 v75, v54, v8
    v_fmac_f32 v91, v54, v11
    v_fmac_f32 v75, v55, v11
    v_fmac_f32 v91, v55, v10
    v_cvt_pk_bf16_f32 v107, v75, v91
    ds_write_b32 v26, v107 offset:416
    buffer_load_dwordx4 a[60:63], v7, s[4:7], s59 offen offset:1024 sc1
    v_fmac_f32 v76, v56, v8
    v_fmac_f32 v92, v56, v11
    v_fmac_f32 v76, v57, v11
    v_fmac_f32 v92, v57, v10
    v_cvt_pk_bf16_f32 v108, v76, v92
    ds_write_b32 v26, v108 offset:48
    v_fmac_f32 v77, v58, v8
    v_fmac_f32 v93, v58, v11
    v_fmac_f32 v77, v59, v11
    v_fmac_f32 v93, v59, v10
    v_cvt_pk_bf16_f32 v109, v77, v93
    ds_write_b32 v26, v109 offset:176
    v_fmac_f32 v78, v60, v8
    v_fmac_f32 v94, v60, v11
    v_fmac_f32 v78, v61, v11
    v_fmac_f32 v94, v61, v10
    v_cvt_pk_bf16_f32 v110, v78, v94
    ds_write_b32 v26, v110 offset:304
    v_fmac_f32 v79, v62, v8
    v_fmac_f32 v95, v62, v11
    v_fmac_f32 v79, v63, v11
    v_fmac_f32 v95, v63, v10
    v_cvt_pk_bf16_f32 v111, v79, v95
    ds_write_b32 v26, v111 offset:432
    s_waitcnt lgkmcnt(0)
    ds_read_b128 v[112:115], v27 offset:0
    ds_read_b128 v[116:119], v27 offset:1056
    ds_read_b128 v[120:123], v27 offset:2112
    ds_read_b128 v[124:127], v27 offset:3168
    s_waitcnt lgkmcnt(3)
    buffer_store_dwordx4 v[112:115], v7, s[4:7], s20 offen offset:0 sc1
    s_waitcnt lgkmcnt(2)
    buffer_store_dwordx4 v[116:119], v7, s[4:7], s20 offen offset:1024 sc1
    s_waitcnt lgkmcnt(1)
    buffer_store_dwordx4 v[120:123], v7, s[4:7], s20 offen offset:2048 sc1
    s_waitcnt lgkmcnt(0)
    buffer_store_dwordx4 v[124:127], v7, s[4:7], s20 offen offset:3072 sc1
    s_lshl_b32 s3, s47, 6
    s_lshl_b32 s21, s34, 5
    s_add_u32 s21, s21, s3
    v_add_u32 v6, s21, v2
    s_cmp_eq_u64 s[22:23], 0
    s_cbranch_scc1 L_A_cfok
    s_lshl_b32 s3, s47, 12
    s_add_u32 s59, s3, 458752
    s_mov_b32 s99, 0
L_poll_3:
    buffer_load_dword v30, v29, s[4:7], s59 offen sc1
    s_waitcnt vmcnt(0)
    v_cmp_ne_u32 vcc, s12, v30
    s_cbranch_vccz L_polld_4
    s_sleep 3
    s_add_u32 s99, s99, 1
    s_cmp_lt_u32 s99, 20000
    s_cbranch_scc1 L_poll_3
L_polld_4:
L_A_cfok:
    s_lshl_b32 s3, s46, 1
    s_add_u32 s22, s3, s63
    s_waitcnt vmcnt(0)
    s_barrier
    s_cmp_eq_u32 s13, 0
    s_cbranch_scc0 L_A_noflag
    s_lshl_b32 s3, s44, 4
    s_add_u32 s3, s3, s45
    s_lshl_b32 s3, s3, 7
    s_add_u32 s3, s3, 65536
    v_mov_b32 v30, s12
    v_mov_b32_e64 v31, 0
    s_mov_b64 exec, 1
    buffer_store_dword v30, v31, s[4:7], s3 offen sc1
    s_mov_b64 exec, -1
L_A_noflag:
    s_add_u32 s3, s35, 8
    s_and_b32 s3, s3, 15
    s_lshl_b32 s3, s3, 10
    s_add_u32 s58, s60, s3
    s_add_u32 s59, s61, s3
    buffer_load_dwordx4 a[64:67], v7, s[4:7], s58 offen offset:0 sc1
    buffer_load_dwordx4 a[68:71], v7, s[4:7], s59 offen offset:0 sc1
    buffer_load_dwordx4 a[72:75], v7, s[4:7], s58 offen offset:1024 sc1
    buffer_load_dwordx4 a[76:79], v7, s[4:7], s59 offen offset:1024 sc1
    s_add_u32 s3, s35, 10
    s_and_b32 s3, s3, 15
    s_lshl_b32 s3, s3, 10
    s_add_u32 s58, s60, s3
    s_add_u32 s59, s61, s3
    buffer_load_dwordx4 a[80:83], v7, s[4:7], s58 offen offset:0 sc1
    buffer_load_dwordx4 a[84:87], v7, s[4:7], s59 offen offset:0 sc1
    buffer_load_dwordx4 a[88:91], v7, s[4:7], s58 offen offset:1024 sc1
    buffer_load_dwordx4 a[92:95], v7, s[4:7], s59 offen offset:1024 sc1
    s_add_u32 s3, s35, 12
    s_and_b32 s3, s3, 15
    s_lshl_b32 s3, s3, 10
    s_add_u32 s58, s60, s3
    s_add_u32 s59, s61, s3
    buffer_load_dwordx4 a[96:99], v7, s[4:7], s58 offen offset:0 sc1
    buffer_load_dwordx4 a[100:103], v7, s[4:7], s59 offen offset:0 sc1
    buffer_load_dwordx4 a[104:107], v7, s[4:7], s58 offen offset:1024 sc1
    buffer_load_dwordx4 a[108:111], v7, s[4:7], s59 offen offset:1024 sc1
    s_add_u32 s3, s35, 14
    s_and_b32 s3, s3, 15
    s_lshl_b32 s3, s3, 10
    s_add_u32 s58, s60, s3
    s_add_u32 s59, s61, s3
    buffer_load_dwordx4 a[112:115], v7, s[4:7], s58 offen offset:0 sc1
    buffer_load_dwordx4 a[116:119], v7, s[4:7], s59 offen offset:0 sc1
    buffer_load_dwordx4 a[120:123], v7, s[4:7], s58 offen offset:1024 sc1
    buffer_load_dwordx4 a[124:127], v7, s[4:7], s59 offen offset:1024 sc1
    v_and_b32 v29, 3, v1
    s_lshl_b32 s3, s13, 2
    v_add_u32 v29, s3, v29
    v_lshlrev_b32_e64 v29, 7, v29
    s_lshr_b32 s3, s46, 1
    s_lshl_b32 s3, s3, 11
    s_add_u32 s59, s3, 65536
    s_lshl_b32 s3, s46, 1
    s_add_u32 s3, s3, s63
    s_lshl_b32 s60, s3, 6
    s_xor_b32 s3, s3, 1
    s_lshl_b32 s61, s3, 6
    s_lshl_b32 s3, s13, 4
    s_add_u32 s60, s60, s3
    s_add_u32 s61, s61, s3
    s_lshl_b32 s60, s60, 10
    s_lshl_b32 s61, s61, 10
    s_add_u32 s60, s60, 4194304
    s_add_u32 s61, s61, 4194304
    s_mov_b32 s99, 0
L_poll_5:
    buffer_load_dword v30, v29, s[4:7], s59 offen sc1
    s_waitcnt vmcnt(0)
    v_cmp_ne_u32 vcc, s12, v30
    s_cbranch_vccz L_polld_6
    s_sleep 3
    s_add_u32 s99, s99, 1
    s_cmp_lt_u32 s99, 20000
    s_cbranch_scc1 L_poll_5
L_polld_6:
    s_barrier
    s_add_u32 s3, s35, 0
    s_and_b32 s3, s3, 15
    s_lshl_b32 s3, s3, 10
    s_add_u32 s58, s60, s3
    s_add_u32 s59, s61, s3
    buffer_load_dwordx4 v[8:11], v7, s[4:7], s58 offen offset:0 sc1
    buffer_load_dwordx4 v[12:15], v7, s[4:7], s59 offen offset:0 sc1
    buffer_load_dwordx4 v[16:19], v7, s[4:7], s58 offen offset:1024 sc1
    buffer_load_dwordx4 v[20:23], v7, s[4:7], s59 offen offset:1024 sc1
    s_add_u32 s3, s35, 2
    s_and_b32 s3, s3, 15
    s_lshl_b32 s3, s3, 10
    s_add_u32 s58, s60, s3
    s_add_u32 s59, s61, s3
    buffer_load_dwordx4 v[24:27], v7, s[4:7], s58 offen offset:0 sc1
    buffer_load_dwordx4 v[28:31], v7, s[4:7], s59 offen offset:0 sc1
    buffer_load_dwordx4 v[32:35], v7, s[4:7], s58 offen offset:1024 sc1
    buffer_load_dwordx4 v[36:39], v7, s[4:7], s59 offen offset:1024 sc1
    s_add_u32 s3, s35, 4
    s_and_b32 s3, s3, 15
    s_lshl_b32 s3, s3, 10
    s_add_u32 s58, s60, s3
    s_add_u32 s59, s61, s3
    buffer_load_dwordx4 v[40:43], v7, s[4:7], s58 offen offset:0 sc1
    buffer_load_dwordx4 v[44:47], v7, s[4:7], s59 offen offset:0 sc1
    buffer_load_dwordx4 v[48:51], v7, s[4:7], s58 offen offset:1024 sc1
    buffer_load_dwordx4 v[52:55], v7, s[4:7], s59 offen offset:1024 sc1
    s_add_u32 s3, s35, 6
    s_and_b32 s3, s3, 15
    s_lshl_b32 s3, s3, 10
    s_add_u32 s58, s60, s3
    s_add_u32 s59, s61, s3
    buffer_load_dwordx4 v[56:59], v7, s[4:7], s58 offen offset:0 sc1
    buffer_load_dwordx4 v[60:63], v7, s[4:7], s59 offen offset:0 sc1
    s_waitcnt vmcnt(12)
    v_mfma_f32_32x32x16_bf16 v[64:79], v[8:11], a[0:3], 0
    v_mfma_f32_32x32x16_bf16 v[80:95], v[8:11], a[4:7], 0
    v_mfma_f32_32x32x16_bf16 v[96:111], v[12:15], a[0:3], 0
    v_mfma_f32_32x32x16_bf16 v[112:127], v[12:15], a[4:7], 0
    s_waitcnt vmcnt(10)
    v_mfma_f32_32x32x16_bf16 v[64:79], v[16:19], a[8:11], v[64:79]
    buffer_load_dwordx4 v[8:11], v7, s[4:7], s58 offen offset:1024 sc1
    v_mfma_f32_32x32x16_bf16 v[80:95], v[16:19], a[12:15], v[80:95]
    buffer_load_dwordx4 v[12:15], v7, s[4:7], s59 offen offset:1024 sc1
    v_mfma_f32_32x32x16_bf16 v[96:111], v[20:23], a[8:11], v[96:111]
    v_mfma_f32_32x32x16_bf16 v[112:127], v[20:23], a[12:15], v[112:127]
    s_waitcnt vmcnt(10)
    v_mfma_f32_32x32x16_bf16 v[64:79], v[24:27], a[16:19], v[64:79]
    s_add_u32 s3, s35, 8
    s_and_b32 s3, s3, 15
    s_lshl_b32 s3, s3, 10
    s_add_u32 s58, s60, s3
    s_add_u32 s59, s61, s3
    buffer_load_dwordx4 v[16:19], v7, s[4:7], s58 offen offset:0 sc1
    v_mfma_f32_32x32x16_bf16 v[80:95], v[24:27], a[20:23], v[80:95]
    buffer_load_dwordx4 v[20:23], v7, s[4:7], s59 offen offset:0 sc1
    v_mfma_f32_32x32x16_bf16 v[96:111], v[28:31], a[16:19], v[96:111]
    v_mfma_f32_32x32x16_bf16 v[112:127], v[28:31], a[20:23], v[112:127]
    s_waitcnt vmcnt(10)
    v_mfma_f32_32x32x16_bf16 v[64:79], v[32:35], a[24:27], v[64:79]
    buffer_load_dwordx4 v[24:27], v7, s[4:7], s58 offen offset:1024 sc1
    v_mfma_f32_32x32x16_bf16 v[80:95], v[32:35], a[28:31], v[80:95]
    buffer_load_dwordx4 v[28:31], v7, s[4:7], s59 offen offset:1024 sc1
    v_mfma_f32_32x32x16_bf16 v[96:111], v[36:39], a[24:27], v[96:111]
    v_mfma_f32_32x32x16_bf16 v[112:127], v[36:39], a[28:31], v[112:127]
    s_waitcnt vmcnt(10)
    v_mfma_f32_32x32x16_bf16 v[64:79], v[40:43], a[32:35], v[64:79]
    s_add_u32 s3, s35, 10
    s_and_b32 s3, s3, 15
    s_lshl_b32 s3, s3, 10
    s_add_u32 s58, s60, s3
    s_add_u32 s59, s61, s3
    buffer_load_dwordx4 v[32:35], v7, s[4:7], s58 offen offset:0 sc1
    v_mfma_f32_32x32x16_bf16 v[80:95], v[40:43], a[36:39], v[80:95]
    buffer_load_dwordx4 v[36:39], v7, s[4:7], s59 offen offset:0 sc1
    v_mfma_f32_32x32x16_bf16 v[96:111], v[44:47], a[32:35], v[96:111]
    v_mfma_f32_32x32x16_bf16 v[112:127], v[44:47], a[36:39], v[112:127]
    s_waitcnt vmcnt(10)
    v_mfma_f32_32x32x16_bf16 v[64:79], v[48:51], a[40:43], v[64:79]
    buffer_load_dwordx4 v[40:43], v7, s[4:7], s58 offen offset:1024 sc1
    v_mfma_f32_32x32x16_bf16 v[80:95], v[48:51], a[44:47], v[80:95]
    buffer_load_dwordx4 v[44:47], v7, s[4:7], s59 offen offset:1024 sc1
    v_mfma_f32_32x32x16_bf16 v[96:111], v[52:55], a[40:43], v[96:111]
    v_mfma_f32_32x32x16_bf16 v[112:127], v[52:55], a[44:47], v[112:127]
    s_waitcnt vmcnt(10)
    v_mfma_f32_32x32x16_bf16 v[64:79], v[56:59], a[48:51], v[64:79]
    s_add_u32 s3, s35, 12
    s_and_b32 s3, s3, 15
    s_lshl_b32 s3, s3, 10
    s_add_u32 s58, s60, s3
    s_add_u32 s59, s61, s3
    buffer_load_dwordx4 v[48:51], v7, s[4:7], s58 offen offset:0 sc1
    v_mfma_f32_32x32x16_bf16 v[80:95], v[56:59], a[52:55], v[80:95]
    buffer_load_dwordx4 v[52:55], v7, s[4:7], s59 offen offset:0 sc1
    v_mfma_f32_32x32x16_bf16 v[96:111], v[60:63], a[48:51], v[96:111]
    v_mfma_f32_32x32x16_bf16 v[112:127], v[60:63], a[52:55], v[112:127]
    s_waitcnt vmcnt(10)
    v_mfma_f32_32x32x16_bf16 v[64:79], v[8:11], a[56:59], v[64:79]
    buffer_load_dwordx4 v[56:59], v7, s[4:7], s58 offen offset:1024 sc1
    v_mfma_f32_32x32x16_bf16 v[80:95], v[8:11], a[60:63], v[80:95]
    buffer_load_dwordx4 v[60:63], v7, s[4:7], s59 offen offset:1024 sc1
    v_mfma_f32_32x32x16_bf16 v[96:111], v[12:15], a[56:59], v[96:111]
    v_mfma_f32_32x32x16_bf16 v[112:127], v[12:15], a[60:63], v[112:127]
    s_waitcnt vmcnt(10)
    v_mfma_f32_32x32x16_bf16 v[64:79], v[16:19], a[64:67], v[64:79]
    s_add_u32 s3, s35, 14
    s_and_b32 s3, s3, 15
    s_lshl_b32 s3, s3, 10
    s_add_u32 s58, s60, s3
    s_add_u32 s59, s61, s3
    buffer_load_dwordx4 v[8:11], v7, s[4:7], s58 offen offset:0 sc1
    v_mfma_f32_32x32x16_bf16 v[80:95], v[16:19], a[68:71], v[80:95]
    buffer_load_dwordx4 v[12:15], v7, s[4:7], s59 offen offset:0 sc1
    v_mfma_f32_32x32x16_bf16 v[96:111], v[20:23], a[64:67], v[96:111]
    v_mfma_f32_32x32x16_bf16 v[112:127], v[20:23], a[68:71], v[112:127]
    s_waitcnt vmcnt(10)
    v_mfma_f32_32x32x16_bf16 v[64:79], v[24:27], a[72:75], v[64:79]
    buffer_load_dwordx4 v[16:19], v7, s[4:7], s58 offen offset:1024 sc1
    v_mfma_f32_32x32x16_bf16 v[80:95], v[24:27], a[76:79], v[80:95]
    buffer_load_dwordx4 v[20:23], v7, s[4:7], s59 offen offset:1024 sc1
    v_mfma_f32_32x32x16_bf16 v[96:111], v[28:31], a[72:75], v[96:111]
    v_mfma_f32_32x32x16_bf16 v[112:127], v[28:31], a[76:79], v[112:127]
    s_waitcnt vmcnt(10)
    v_mfma_f32_32x32x16_bf16 v[64:79], v[32:35], a[80:83], v[64:79]
    v_and_b32 v30, 7, v1
    s_lshl_b32 s3, s13, 3
    v_add_u32 v29, s3, v30
    v_lshlrev_b32 v29, 7, v29
    s_lshl_b32 s3, s47, 12
    s_add_u32 s20, s3, 131072
    v_mfma_f32_32x32x16_bf16 v[80:95], v[32:35], a[84:87], v[80:95]
    v_bfe_u32 v31, v1, 3, 1
    s_lshl_b32 s3, s13, 1
    v_add_u32 v31, s3, v31
    v_lshlrev_b32_e64 v31, 10, v31
    v_lshl_add_u32 v31, v30, 3, v31
    s_and_b32 s3, s46, 3
    v_mfma_f32_32x32x16_bf16 v[96:111], v[36:39], a[80:83], v[96:111]
    s_lshl_b32 s3, s3, 6
    s_lshr_b32 s21, s46, 2
    s_add_u32 s3, s3, s21
    s_lshl_b32 s3, s3, 7
    s_add_u32 s21, s3, 327680
    v_lshlrev_b32 v28, 1, v6
    v_mfma_f32_32x32x16_bf16 v[112:127], v[36:39], a[84:87], v[112:127]
    buffer_load_dword v30, v29, s[4:7], s20 offen sc1
    s_waitcnt vmcnt(9)
    v_mfma_f32_32x32x16_bf16 v[64:79], v[40:43], a[88:91], v[64:79]
    v_mfma_f32_32x32x16_bf16 v[80:95], v[40:43], a[92:95], v[80:95]
    v_mfma_f32_32x32x16_bf16 v[96:111], v[44:47], a[88:91], v[96:111]
    v_mfma_f32_32x32x16_bf16 v[112:127], v[44:47], a[92:95], v[112:127]
    s_waitcnt vmcnt(7)
    v_mfma_f32_32x32x16_bf16 v[64:79], v[48:51], a[96:99], v[64:79]
    v_mfma_f32_32x32x16_bf16 v[80:95], v[48:51], a[100:103], v[80:95]
    v_mfma_f32_32x32x16_bf16 v[96:111], v[52:55], a[96:99], v[96:111]
    v_mfma_f32_32x32x16_bf16 v[112:127], v[52:55], a[100:103], v[112:127]
    s_waitcnt vmcnt(5)
    v_mfma_f32_32x32x16_bf16 v[64:79], v[56:59], a[104:107], v[64:79]
    buffer_load_dwordx2 v[50:51], v31, s[4:7], s21 offen sc1
    global_load_ushort v48, v28, s[30:31]
    global_load_ushort v49, v28, s[32:33]
    v_lshl_add_u32 v28, v3, 14, v28
    s_lshl_b32 s23, s22, 15
    v_mfma_f32_32x32x16_bf16 v[80:95], v[56:59], a[108:111], v[80:95]
    buffer_load_ushort v32, v28, s[8:11], s23 offen offset:0
    v_mfma_f32_32x32x16_bf16 v[96:111], v[60:63], a[104:107], v[96:111]
    buffer_load_ushort v36, v28, s[8:11], s23 offen offset:1024
    v_mfma_f32_32x32x16_bf16 v[112:127], v[60:63], a[108:111], v[112:127]
    buffer_load_ushort v40, v28, s[8:11], s23 offen offset:2048
    s_waitcnt vmcnt(9)
    v_mfma_f32_32x32x16_bf16 v[64:79], v[8:11], a[112:115], v[64:79]
    buffer_load_ushort v44, v28, s[8:11], s23 offen offset:3072
    s_add_u32 s23, s23, 4096
    v_mfma_f32_32x32x16_bf16 v[80:95], v[8:11], a[116:119], v[80:95]
    buffer_load_ushort v33, v28, s[8:11], s23 offen offset:0
    buffer_load_ushort v37, v28, s[8:11], s23 offen offset:1024
    v_mfma_f32_32x32x16_bf16 v[96:111], v[12:15], a[112:115], v[96:111]
    buffer_load_ushort v41, v28, s[8:11], s23 offen offset:2048
    v_mfma_f32_32x32x16_bf16 v[112:127], v[12:15], a[116:119], v[112:127]
    buffer_load_ushort v45, v28, s[8:11], s23 offen offset:3072
    s_add_u32 s23, s23, 4096
    buffer_load_ushort v34, v28, s[8:11], s23 offen offset:0
    s_waitcnt vmcnt(13)
    v_mfma_f32_32x32x16_bf16 v[64:79], v[16:19], a[120:123], v[64:79]
    buffer_load_ushort v38, v28, s[8:11], s23 offen offset:1024
    buffer_load_ushort v42, v28, s[8:11], s23 offen offset:2048
    v_mfma_f32_32x32x16_bf16 v[80:95], v[16:19], a[124:127], v[80:95]
    buffer_load_ushort v46, v28, s[8:11], s23 offen offset:3072
    s_add_u32 s23, s23, 4096
    buffer_load_ushort v35, v28, s[8:11], s23 offen offset:0
    v_mfma_f32_32x32x16_bf16 v[96:111], v[20:23], a[120:123], v[96:111]
    buffer_load_ushort v39, v28, s[8:11], s23 offen offset:1024
    buffer_load_ushort v43, v28, s[8:11], s23 offen offset:2048
    v_mfma_f32_32x32x16_bf16 v[112:127], v[20:23], a[124:127], v[112:127]
    buffer_load_ushort v47, v28, s[8:11], s23 offen offset:3072
    s_xor_b32 s3, s13, 1
    s_mul_i32 s3, s3, 12288
    s_add_u32 s3, s3, 24576
    v_add_u32 v16, s3, v7
    ds_write_b128 v16, v[80:83] offset:0
    ds_write_b128 v16, v[84:87] offset:1024
    ds_write_b128 v16, v[88:91] offset:2048
    ds_write_b128 v16, v[92:95] offset:3072
    s_xor_b32 s3, s13, 2
    s_mul_i32 s3, s3, 12288
    s_add_u32 s3, s3, 28672
    v_add_u32 v16, s3, v7
    ds_write_b128 v16, v[96:99] offset:0
    ds_write_b128 v16, v[100:103] offset:1024
    ds_write_b128 v16, v[104:107] offset:2048
    ds_write_b128 v16, v[108:111] offset:3072
    s_xor_b32 s3, s13, 3
    s_mul_i32 s3, s3, 12288
    s_add_u32 s3, s3, 32768
    v_add_u32 v16, s3, v7
    ds_write_b128 v16, v[112:115] offset:0
    ds_write_b128 v16, v[116:119] offset:1024
    ds_write_b128 v16, v[120:123] offset:2048
    ds_write_b128 v16, v[124:127] offset:3072
    s_mul_i32 s3, s13, 12288
    s_add_u32 s3, s3, 24576
    v_add_u32 v17, s3, v7
    v_lshrrev_b32 v18, 1, v6
    v_lshlrev_b32 v18, 13, v18
    v_and_b32 v19, 1, v6
    v_lshl_add_u32 v18, v19, 6, v18
    v_lshl_add_u32 v18, v3, 5, v18
    s_lshl_b32 s3, s22, 7
    s_add_u32 s56, s3, 8388608
    s_waitcnt vmcnt(18)
    v_cmp_ne_u32_e64 vcc, s12, v30
    s_cbranch_vccz L_A_ybok
    s_mov_b32 s99, 0
L_poll_7:
    buffer_load_dword v30, v29, s[4:7], s20 offen sc1
    s_waitcnt vmcnt(0)
    v_cmp_ne_u32_e64 vcc, s12, v30
    s_cbranch_vccz L_polld_8
    s_sleep 3
    s_add_u32 s99, s99, 1
    s_cmp_lt_u32 s99, 20000
    s_cbranch_scc1 L_poll_7
L_polld_8:
L_A_ybok:
    v_cmp_ne_u32 vcc, s12, v51
    s_cbranch_vccz L_A_gpd
    s_mov_b32 s99, 0
L_A_gp:
    buffer_load_dwordx2 v[50:51], v31, s[4:7], s21 offen sc1
    s_waitcnt vmcnt(0)
    v_cmp_ne_u32_e64 vcc, s12, v51
    s_cbranch_vccz L_A_gpd
    s_sleep 3
    s_add_u32 s99, s99, 1
    s_cmp_lt_u32 s99, 20000
    s_cbranch_scc1 L_A_gp
L_A_gpd:
    v_sub_f32 v51, 1.0, v50
    v_cvt_pk_bf16_f32 v51, v51, v51
    v_lshlrev_b32 v51, 16, v51
    v_and_b32_e64 v19, 15, v1
    s_lshl_b32 s3, s13, 6
    s_add_u32 s3, s3, 21504
    v_lshl_add_u32 v19, v19, 2, s3
    ds_write_b32 v19, v50
    ds_write_b32 v19, v51 offset:256
    s_lshl_b32 s3, s63, 7
    s_add_u32 s3, s3, 21504
    v_lshl_add_u32 v20, v3, 6, s3
    v_and_b32 v19, 3, v1
    v_sub_u32 v21, v6, v19
    v_lshlrev_b32 v21, 2, v21
    v_lshl_add_u32 v21, v19, 11, v21
    v_lshl_add_u32 v21, v3, 15, v21
    s_lshl_b32 s57, s22, 16
    s_waitcnt lgkmcnt(0)
    s_barrier
    buffer_load_dwordx4 v[8:11], v18, s[4:7], s56 offen sc1
    buffer_load_dwordx4 v[12:15], v18, s[4:7], s56 offen offset:16 sc1
    ds_read_b128 v[80:83], v17 offset:0
    ds_read_b128 v[84:87], v17 offset:1024
    ds_read_b128 v[88:91], v17 offset:2048
    ds_read_b128 v[92:95], v17 offset:3072
    ds_read_b128 v[96:99], v17 offset:4096
    ds_read_b128 v[100:103], v17 offset:5120
    ds_read_b128 v[104:107], v17 offset:6144
    ds_read_b128 v[108:111], v17 offset:7168
    ds_read_b128 v[112:115], v17 offset:8192
    ds_read_b128 v[116:119], v17 offset:9216
    ds_read_b128 v[120:123], v17 offset:10240
    ds_read_b128 v[124:127], v17 offset:11264
    s_waitcnt lgkmcnt(8)
    v_add_f32 v64, v64, v80
    v_add_f32 v65, v65, v81
    v_add_f32 v66, v66, v82
    v_add_f32 v67, v67, v83
    v_add_f32 v68, v68, v84
    v_add_f32 v69, v69, v85
    v_add_f32 v70, v70, v86
    v_add_f32 v71, v71, v87
    v_add_f32 v72, v72, v88
    v_add_f32 v73, v73, v89
    v_add_f32 v74, v74, v90
    v_add_f32 v75, v75, v91
    v_add_f32 v76, v76, v92
    v_add_f32 v77, v77, v93
    v_add_f32 v78, v78, v94
    v_add_f32 v79, v79, v95
    s_waitcnt lgkmcnt(4)
    v_add_f32 v64, v64, v96
    v_add_f32 v65, v65, v97
    v_add_f32 v66, v66, v98
    v_add_f32 v67, v67, v99
    v_add_f32 v68, v68, v100
    v_add_f32 v69, v69, v101
    v_add_f32 v70, v70, v102
    v_add_f32 v71, v71, v103
    v_add_f32 v72, v72, v104
    v_add_f32 v73, v73, v105
    v_add_f32 v74, v74, v106
    v_add_f32 v75, v75, v107
    v_add_f32 v76, v76, v108
    v_add_f32 v77, v77, v109
    v_add_f32 v78, v78, v110
    v_add_f32 v79, v79, v111
    s_waitcnt lgkmcnt(0)
    v_add_f32 v64, v64, v112
    v_add_f32 v65, v65, v113
    v_add_f32 v66, v66, v114
    v_add_f32 v67, v67, v115
    v_add_f32 v68, v68, v116
    v_add_f32 v69, v69, v117
    v_add_f32 v70, v70, v118
    v_add_f32 v71, v71, v119
    v_add_f32 v72, v72, v120
    v_add_f32 v73, v73, v121
    v_add_f32 v74, v74, v122
    v_add_f32 v75, v75, v123
    v_add_f32 v76, v76, v124
    v_add_f32 v77, v77, v125
    v_add_f32 v78, v78, v126
    v_add_f32 v79, v79, v127
    ds_read_b128 v[80:83], v20 offset:0
    ds_read_b128 v[96:99], v20 offset:256
    ds_read_b128 v[84:87], v20 offset:16
    ds_read_b128 v[100:103], v20 offset:272
    ds_read_b128 v[88:91], v20 offset:32
    ds_read_b128 v[104:107], v20 offset:288
    ds_read_b128 v[92:95], v20 offset:48
    ds_read_b128 v[108:111], v20 offset:304
    s_mov_b32 s21, 0xffff0000
    s_waitcnt vmcnt(2)
    v_lshlrev_b32 v48, 16, v48
    v_lshlrev_b32 v49, 16, v49
    s_waitcnt lgkmcnt(0)
    v_lshlrev_b32 v52, 16, v32
    v_mul_f32 v53, v52, v48
    v_mul_f32_e64 v54, v52, v49
    v_cvt_pk_bf16_f32 v32, v53, v54
    v_lshlrev_b32 v53, 16, v32
    v_add_f32 v64, v64, v53
    v_mul_f32 v64, v80, v64
    v_lshlrev_b32 v52, 16, v33
    v_mul_f32 v53, v52, v48
    v_mul_f32 v54, v52, v49
    v_cvt_pk_bf16_f32 v33, v53, v54
    v_lshlrev_b32 v53, 16, v33
    v_add_f32 v65, v65, v53
    v_mul_f32 v65, v84, v65
    v_lshlrev_b32 v52, 16, v34
    v_mul_f32 v53, v52, v48
    v_mul_f32 v54, v52, v49
    v_cvt_pk_bf16_f32 v34, v53, v54
    v_lshlrev_b32 v53, 16, v34
    v_add_f32 v66, v66, v53
    v_mul_f32 v66, v88, v66
    v_lshlrev_b32 v52, 16, v35
    v_mul_f32 v53, v52, v48
    v_mul_f32 v54, v52, v49
    v_cvt_pk_bf16_f32 v35, v53, v54
    v_lshlrev_b32 v53, 16, v35
    v_add_f32 v67, v67, v53
    v_mul_f32 v67, v92, v67
    v_lshlrev_b32 v52, 16, v36
    v_mul_f32 v53, v52, v48
    v_mul_f32 v54, v52, v49
    v_cvt_pk_bf16_f32 v36, v53, v54
    v_lshlrev_b32 v53, 16, v36
    v_add_f32 v68, v68, v53
    v_mul_f32 v68, v81, v68
    v_lshlrev_b32 v52, 16, v37
    v_mul_f32 v53, v52, v48
    v_mul_f32 v54, v52, v49
    v_cvt_pk_bf16_f32 v37, v53, v54
    v_lshlrev_b32 v53, 16, v37
    v_add_f32 v69, v69, v53
    v_mul_f32 v69, v85, v69
    v_lshlrev_b32 v52, 16, v38
    v_mul_f32 v53, v52, v48
    v_mul_f32 v54, v52, v49
    v_cvt_pk_bf16_f32 v38, v53, v54
    v_lshlrev_b32 v53, 16, v38
    v_add_f32 v70, v70, v53
    v_mul_f32 v70, v89, v70
    v_lshlrev_b32 v52, 16, v39
    v_mul_f32 v53, v52, v48
    v_mul_f32 v54, v52, v49
    v_cvt_pk_bf16_f32 v39, v53, v54
    v_lshlrev_b32 v53, 16, v39
    v_add_f32 v71, v71, v53
    v_mul_f32 v71, v93, v71
    v_lshlrev_b32 v52, 16, v40
    v_mul_f32 v53, v52, v48
    v_mul_f32 v54, v52, v49
    v_cvt_pk_bf16_f32 v40, v53, v54
    v_lshlrev_b32 v53, 16, v40
    v_add_f32 v72, v72, v53
    v_mul_f32 v72, v82, v72
    v_lshlrev_b32 v52, 16, v41
    v_mul_f32 v53, v52, v48
    v_mul_f32 v54, v52, v49
    v_cvt_pk_bf16_f32 v41, v53, v54
    v_lshlrev_b32 v53, 16, v41
    v_add_f32 v73, v73, v53
    v_mul_f32 v73, v86, v73
    v_lshlrev_b32 v52, 16, v42
    v_mul_f32 v53, v52, v48
    v_mul_f32 v54, v52, v49
    v_cvt_pk_bf16_f32 v42, v53, v54
    v_lshlrev_b32 v53, 16, v42
    v_add_f32 v74, v74, v53
    v_mul_f32 v74, v90, v74
    v_lshlrev_b32 v52, 16, v43
    v_mul_f32 v53, v52, v48
    v_mul_f32 v54, v52, v49
    v_cvt_pk_bf16_f32 v43, v53, v54
    v_lshlrev_b32 v53, 16, v43
    v_add_f32 v75, v75, v53
    v_mul_f32 v75, v94, v75
    v_lshlrev_b32 v52, 16, v44
    v_mul_f32 v53, v52, v48
    v_mul_f32 v54, v52, v49
    v_cvt_pk_bf16_f32 v44, v53, v54
    v_lshlrev_b32 v53, 16, v44
    v_add_f32 v76, v76, v53
    v_mul_f32 v76, v83, v76
    v_lshlrev_b32 v52, 16, v45
    v_mul_f32 v53, v52, v48
    v_mul_f32 v54, v52, v49
    v_cvt_pk_bf16_f32 v45, v53, v54
    v_lshlrev_b32 v53, 16, v45
    v_add_f32 v77, v77, v53
    v_mul_f32 v77, v87, v77
    v_lshlrev_b32 v52, 16, v46
    v_mul_f32 v53, v52, v48
    v_mul_f32 v54, v52, v49
    v_cvt_pk_bf16_f32 v46, v53, v54
    v_lshlrev_b32 v53, 16, v46
    v_add_f32 v78, v78, v53
    v_mul_f32 v78, v91, v78
    v_lshlrev_b32 v52, 16, v47
    v_mul_f32 v53, v52, v48
    v_mul_f32 v54, v52, v49
    v_cvt_pk_bf16_f32 v47, v53, v54
    v_lshlrev_b32 v53, 16, v47
    v_add_f32 v79, v79, v53
    v_mul_f32 v79, v95, v79
    s_waitcnt vmcnt(0)
    v_lshlrev_b32 v52, 16, v8
    v_and_b32 v53, s21, v32
    v_add_f32_e64 v52, v52, v53
    v_cvt_pk_bf16_f32 v52, v52, v52
    v_lshlrev_b32 v52, 16, v52
    v_mul_f32 v52, v96, v52
    v_cvt_pk_bf16_f32 v52, v52, v52
    v_lshlrev_b32 v52, 16, v52
    v_add_f32 v64, v64, v52
    v_lshlrev_b32 v52, 16, v10
    v_and_b32 v53, s21, v36
    v_add_f32_e64 v52, v52, v53
    v_cvt_pk_bf16_f32 v52, v52, v52
    v_lshlrev_b32 v52, 16, v52
    v_mul_f32 v52, v97, v52
    v_cvt_pk_bf16_f32 v52, v52, v52
    v_lshlrev_b32 v52, 16, v52
    v_add_f32 v68, v68, v52
    v_lshlrev_b32 v52, 16, v12
    v_and_b32 v53, s21, v40
    v_add_f32_e64 v52, v52, v53
    v_cvt_pk_bf16_f32 v52, v52, v52
    v_lshlrev_b32 v52, 16, v52
    v_mul_f32 v52, v98, v52
    v_cvt_pk_bf16_f32 v52, v52, v52
    v_lshlrev_b32 v52, 16, v52
    v_add_f32 v72, v72, v52
    v_lshlrev_b32 v52, 16, v14
    v_and_b32 v53, s21, v44
    v_add_f32_e64 v52, v52, v53
    v_cvt_pk_bf16_f32 v52, v52, v52
    v_lshlrev_b32 v52, 16, v52
    v_mul_f32 v52, v99, v52
    v_cvt_pk_bf16_f32 v52, v52, v52
    v_lshlrev_b32 v52, 16, v52
    v_add_f32 v76, v76, v52
    s_mov_b32 vcc_lo, 0x55555555
    s_mov_b32 vcc_hi, 0x55555555
    v_cndmask_b32_dpp v24, v68, v64, vcc quad_perm:[1,0,3,2] row_mask:0xf bank_mask:0xf
    v_cndmask_b32_dpp v26, v76, v72, vcc quad_perm:[1,0,3,2] row_mask:0xf bank_mask:0xf
    s_mov_b32 vcc_lo, 0xaaaaaaaa
    s_mov_b32 vcc_hi, 0xaaaaaaaa
    v_cndmask_b32_dpp v25, v64, v68, vcc quad_perm:[1,0,3,2] row_mask:0xf bank_mask:0xf
    v_cndmask_b32_dpp v27, v72, v76, vcc quad_perm:[1,0,3,2] row_mask:0xf bank_mask:0xf
    s_mov_b32 vcc_lo, 0x33333333
    s_mov_b32 vcc_hi, 0x33333333
    v_cndmask_b32_dpp v56, v26, v24, vcc quad_perm:[2,3,0,1] row_mask:0xf bank_mask:0xf
    v_cndmask_b32_dpp v57, v27, v25, vcc quad_perm:[2,3,0,1] row_mask:0xf bank_mask:0xf
    s_mov_b32 vcc_lo, 0xcccccccc
    s_mov_b32 vcc_hi, 0xcccccccc
    v_cndmask_b32_dpp v58, v24, v26, vcc quad_perm:[2,3,0,1] row_mask:0xf bank_mask:0xf
    v_cndmask_b32_dpp v59, v25, v27, vcc quad_perm:[2,3,0,1] row_mask:0xf bank_mask:0xf
    buffer_store_dwordx4 v[56:59], v21, s[36:39], s57 offen sc1
    s_add_u32 s57, s57, 8192
    v_and_b32 v52, s21, v8
    v_and_b32 v53, s21, v33
    v_add_f32_e64 v52, v52, v53
    v_cvt_pk_bf16_f32 v52, v52, v52
    v_lshlrev_b32 v52, 16, v52
    v_mul_f32 v52, v100, v52
    v_cvt_pk_bf16_f32 v52, v52, v52
    v_lshlrev_b32 v52, 16, v52
    v_add_f32 v65, v65, v52
    v_and_b32 v52, s21, v10
    v_and_b32 v53, s21, v37
    v_add_f32_e64 v52, v52, v53
    v_cvt_pk_bf16_f32 v52, v52, v52
    v_lshlrev_b32 v52, 16, v52
    v_mul_f32 v52, v101, v52
    v_cvt_pk_bf16_f32 v52, v52, v52
    v_lshlrev_b32 v52, 16, v52
    v_add_f32 v69, v69, v52
    v_and_b32 v52, s21, v12
    v_and_b32 v53, s21, v41
    v_add_f32_e64 v52, v52, v53
    v_cvt_pk_bf16_f32 v52, v52, v52
    v_lshlrev_b32 v52, 16, v52
    v_mul_f32 v52, v102, v52
    v_cvt_pk_bf16_f32 v52, v52, v52
    v_lshlrev_b32 v52, 16, v52
    v_add_f32 v73, v73, v52
    v_and_b32 v52, s21, v14
    v_and_b32 v53, s21, v45
    v_add_f32_e64 v52, v52, v53
    v_cvt_pk_bf16_f32 v52, v52, v52
    v_lshlrev_b32 v52, 16, v52
    v_mul_f32 v52, v103, v52
    v_cvt_pk_bf16_f32 v52, v52, v52
    v_lshlrev_b32 v52, 16, v52
    v_add_f32 v77, v77, v52
    s_mov_b32 vcc_lo, 0x55555555
    s_mov_b32 vcc_hi, 0x55555555
    v_cndmask_b32_dpp v24, v69, v65, vcc quad_perm:[1,0,3,2] row_mask:0xf bank_mask:0xf
    v_cndmask_b32_dpp v26, v77, v73, vcc quad_perm:[1,0,3,2] row_mask:0xf bank_mask:0xf
    s_mov_b32 vcc_lo, 0xaaaaaaaa
    s_mov_b32 vcc_hi, 0xaaaaaaaa
    v_cndmask_b32_dpp v25, v65, v69, vcc quad_perm:[1,0,3,2] row_mask:0xf bank_mask:0xf
    v_cndmask_b32_dpp v27, v73, v77, vcc quad_perm:[1,0,3,2] row_mask:0xf bank_mask:0xf
    s_mov_b32 vcc_lo, 0x33333333
    s_mov_b32 vcc_hi, 0x33333333
    v_cndmask_b32_dpp v60, v26, v24, vcc quad_perm:[2,3,0,1] row_mask:0xf bank_mask:0xf
    v_cndmask_b32_dpp v61, v27, v25, vcc quad_perm:[2,3,0,1] row_mask:0xf bank_mask:0xf
    s_mov_b32 vcc_lo, 0xcccccccc
    s_mov_b32 vcc_hi, 0xcccccccc
    v_cndmask_b32_dpp v62, v24, v26, vcc quad_perm:[2,3,0,1] row_mask:0xf bank_mask:0xf
    v_cndmask_b32_dpp v63, v25, v27, vcc quad_perm:[2,3,0,1] row_mask:0xf bank_mask:0xf
    buffer_store_dwordx4 v[60:63], v21, s[36:39], s57 offen sc1
    s_add_u32 s57, s57, 8192
    v_lshlrev_b32 v52, 16, v9
    v_and_b32 v53, s21, v34
    v_add_f32_e64 v52, v52, v53
    v_cvt_pk_bf16_f32 v52, v52, v52
    v_lshlrev_b32 v52, 16, v52
    v_mul_f32 v52, v104, v52
    v_cvt_pk_bf16_f32 v52, v52, v52
    v_lshlrev_b32 v52, 16, v52
    v_add_f32 v66, v66, v52
    v_lshlrev_b32 v52, 16, v11
    v_and_b32 v53, s21, v38
    v_add_f32_e64 v52, v52, v53
    v_cvt_pk_bf16_f32 v52, v52, v52
    v_lshlrev_b32 v52, 16, v52
    v_mul_f32 v52, v105, v52
    v_cvt_pk_bf16_f32 v52, v52, v52
    v_lshlrev_b32 v52, 16, v52
    v_add_f32 v70, v70, v52
    v_lshlrev_b32 v52, 16, v13
    v_and_b32 v53, s21, v42
    v_add_f32_e64 v52, v52, v53
    v_cvt_pk_bf16_f32 v52, v52, v52
    v_lshlrev_b32 v52, 16, v52
    v_mul_f32 v52, v106, v52
    v_cvt_pk_bf16_f32 v52, v52, v52
    v_lshlrev_b32 v52, 16, v52
    v_add_f32 v74, v74, v52
    v_lshlrev_b32 v52, 16, v15
    v_and_b32 v53, s21, v46
    v_add_f32_e64 v52, v52, v53
    v_cvt_pk_bf16_f32 v52, v52, v52
    v_lshlrev_b32 v52, 16, v52
    v_mul_f32 v52, v107, v52
    v_cvt_pk_bf16_f32 v52, v52, v52
    v_lshlrev_b32 v52, 16, v52
    v_add_f32 v78, v78, v52
    s_mov_b32 vcc_lo, 0x55555555
    s_mov_b32 vcc_hi, 0x55555555
    v_cndmask_b32_dpp v24, v70, v66, vcc quad_perm:[1,0,3,2] row_mask:0xf bank_mask:0xf
    v_cndmask_b32_dpp v26, v78, v74, vcc quad_perm:[1,0,3,2] row_mask:0xf bank_mask:0xf
    s_mov_b32 vcc_lo, 0xaaaaaaaa
    s_mov_b32 vcc_hi, 0xaaaaaaaa
    v_cndmask_b32_dpp v25, v66, v70, vcc quad_perm:[1,0,3,2] row_mask:0xf bank_mask:0xf
    v_cndmask_b32_dpp v27, v74, v78, vcc quad_perm:[1,0,3,2] row_mask:0xf bank_mask:0xf
    s_mov_b32 vcc_lo, 0x33333333
    s_mov_b32 vcc_hi, 0x33333333
    v_cndmask_b32_dpp v56, v26, v24, vcc quad_perm:[2,3,0,1] row_mask:0xf bank_mask:0xf
    v_cndmask_b32_dpp v57, v27, v25, vcc quad_perm:[2,3,0,1] row_mask:0xf bank_mask:0xf
    s_mov_b32 vcc_lo, 0xcccccccc
    s_mov_b32 vcc_hi, 0xcccccccc
    v_cndmask_b32_dpp v58, v24, v26, vcc quad_perm:[2,3,0,1] row_mask:0xf bank_mask:0xf
    v_cndmask_b32_dpp v59, v25, v27, vcc quad_perm:[2,3,0,1] row_mask:0xf bank_mask:0xf
    buffer_store_dwordx4 v[56:59], v21, s[36:39], s57 offen sc1
    s_add_u32 s57, s57, 8192
    v_and_b32 v52, s21, v9
    v_and_b32 v53, s21, v35
    v_add_f32_e64 v52, v52, v53
    v_cvt_pk_bf16_f32 v52, v52, v52
    v_lshlrev_b32 v52, 16, v52
    v_mul_f32 v52, v108, v52
    v_cvt_pk_bf16_f32 v52, v52, v52
    v_lshlrev_b32 v52, 16, v52
    v_add_f32 v67, v67, v52
    v_and_b32 v52, s21, v11
    v_and_b32 v53, s21, v39
    v_add_f32_e64 v52, v52, v53
    v_cvt_pk_bf16_f32 v52, v52, v52
    v_lshlrev_b32 v52, 16, v52
    v_mul_f32 v52, v109, v52
    v_cvt_pk_bf16_f32 v52, v52, v52
    v_lshlrev_b32 v52, 16, v52
    v_add_f32 v71, v71, v52
    v_and_b32 v52, s21, v13
    v_and_b32 v53, s21, v43
    v_add_f32_e64 v52, v52, v53
    v_cvt_pk_bf16_f32 v52, v52, v52
    v_lshlrev_b32 v52, 16, v52
    v_mul_f32 v52, v110, v52
    v_cvt_pk_bf16_f32 v52, v52, v52
    v_lshlrev_b32 v52, 16, v52
    v_add_f32 v75, v75, v52
    v_and_b32 v52, s21, v15
    v_and_b32 v53, s21, v47
    v_add_f32_e64 v52, v52, v53
    v_cvt_pk_bf16_f32 v52, v52, v52
    v_lshlrev_b32 v52, 16, v52
    v_mul_f32 v52, v111, v52
    v_cvt_pk_bf16_f32 v52, v52, v52
    v_lshlrev_b32 v52, 16, v52
    v_add_f32 v79, v79, v52
    s_mov_b32 vcc_lo, 0x55555555
    s_mov_b32 vcc_hi, 0x55555555
    v_cndmask_b32_dpp v24, v71, v67, vcc quad_perm:[1,0,3,2] row_mask:0xf bank_mask:0xf
    v_cndmask_b32_dpp v26, v79, v75, vcc quad_perm:[1,0,3,2] row_mask:0xf bank_mask:0xf
    s_mov_b32 vcc_lo, 0xaaaaaaaa
    s_mov_b32 vcc_hi, 0xaaaaaaaa
    v_cndmask_b32_dpp v25, v67, v71, vcc quad_perm:[1,0,3,2] row_mask:0xf bank_mask:0xf
    v_cndmask_b32_dpp v27, v75, v79, vcc quad_perm:[1,0,3,2] row_mask:0xf bank_mask:0xf
    s_mov_b32 vcc_lo, 0x33333333
    s_mov_b32 vcc_hi, 0x33333333
    v_cndmask_b32_dpp v60, v26, v24, vcc quad_perm:[2,3,0,1] row_mask:0xf bank_mask:0xf
    v_cndmask_b32_dpp v61, v27, v25, vcc quad_perm:[2,3,0,1] row_mask:0xf bank_mask:0xf
    s_mov_b32 vcc_lo, 0xcccccccc
    s_mov_b32 vcc_hi, 0xcccccccc
    v_cndmask_b32_dpp v62, v24, v26, vcc quad_perm:[2,3,0,1] row_mask:0xf bank_mask:0xf
    v_cndmask_b32_dpp v63, v25, v27, vcc quad_perm:[2,3,0,1] row_mask:0xf bank_mask:0xf
    buffer_store_dwordx4 v[60:63], v21, s[36:39], s57 offen sc1
    s_branch L_end
.p2align 6
L_roleB:
    s_setprio 3
    s_load_dwordx8 s[24:31], s[0:1], 80
    s_load_dwordx4 s[32:35], s[0:1], 112
    s_load_dwordx2 s[36:37], s[0:1], 128
    s_mov_b32 s38, s2
    s_lshr_b32 s39, s13, 1
    s_and_b32 s40, s13, 1
    s_lshl_b32 s41, s14, 6
    s_lshl_b32 s42, s15, 1
    s_add_u32 s41, s41, s42
    s_add_u32 s41, s41, s39
    s_lshl_b32 s42, s41, 8
    s_lshl_b32 s43, s40, 7
    s_add_u32 s42, s42, s43
    v_lshl_add_u32 v2, v1, 1, s42
    s_lshl_b32 s43, s41, 1
    v_mov_b32 v3, s43
    v_lshrrev_b32 v4, 3, v1
    v_sub_u32 v5, 7, v4
    v_lshlrev_b32 v5, 10, v5
    v_and_b32_e64 v6, 7, v1
    v_lshl_add_u32 v5, v6, 4, v5
    s_lshr_b32 s44, s38, 4
    s_and_b32 s45, s38, 15
    s_lshl_b32 s45, s45, 2
    s_add_u32 s45, s45, s13
    v_and_b32 v7, 31, v1
    v_lshrrev_b32 v8, 5, v1
    s_lshl_b32 s46, s44, 5
    s_lshl_b32 s47, s40, 4
    s_add_u32 s46, s46, s47
    v_lshrrev_b32 v9, 2, v1
    v_add_u32 v9, s46, v9
    v_lshlrev_b32 v9, 10, v9
    v_and_b32_e64 v10, 3, v1
    v_lshl_add_u32 v9, v10, 4, v9
    s_and_b32 s46, s38, 15
    s_lshl_b32 s46, s46, 6
    v_add_u32 v9, s46, v9
    v_lshlrev_b32_e64 v10, 4, v1
    s_lshr_b32 s61, s15, 3
    s_lshl_b32 s46, s14, 2
    s_add_u32 s61, s61, s46
    s_and_b32 s62, s15, 7
    s_lshl_b32 s46, s61, 6
    s_add_u32 s46, s46, 56
    s_lshl_b32 s47, s13, 4
    s_sub_u32 s46, s46, s47
    s_lshl_b32 s46, s46, 10
    s_lshl_b32 s47, s62, 7
    s_add_u32 s46, s46, s47
    s_mul_i32 s47, s13, 2080
    s_sub_u32 s48, s46, 8192
    s_waitcnt lgkmcnt(0)
    s_load_dword s12, s[4:5], 0x0
    global_load_ushort v12, v2, s[24:25]
    global_load_ushort v13, v2, s[26:27]
    global_load_ushort v16, v3, s[32:33]
    global_load_ushort v14, v2, s[28:29]
    global_load_ushort v15, v2, s[30:31]
    s_add_u32 m0, s47, 8960
    s_nop 0
    buffer_load_dwordx4 v5, s[8:11], s46 offen lds
    s_add_u32 m0, s47, 10000
    s_nop 0
    buffer_load_dwordx4 v5, s[8:11], s48 offen lds
    s_setprio 0
    s_cmp_lt_u32 s13, 2
    s_cselect_b32 s50, s20, s22
    s_cselect_b32 s51, s21, s23
    s_lshl_b32 s47, s13, 10
    s_add_u32 m0, s47, 17408
    s_nop 0
    global_load_lds_dwordx4 v9, s[50:51]
    s_setprio 0
    v_mov_b32 v40, 0
    v_mov_b32 v41, 0
    v_mov_b32 v42, 0
    v_mov_b32 v43, 0
    v_cmp_gt_u32 vcc, 16, v1
    v_lshlrev_b32 v44, 4, v1
    v_add_u32 v45, 4096, v44
    v_cndmask_b32_e64 v44, v45, v44, vcc
    s_mul_i32 s46, s39, 4480
    v_add_u32 v44, s46, v44
    v_cmp_gt_u32 vcc, 20, v1
    s_nop 0
    s_and_saveexec_b64 s[50:51], vcc
    ds_write_b128 v44, v[40:43] offset:0
    s_mov_b64 exec, s[50:51]
    v_mul_u32_u24 v44, 1040, v6
    s_lshl_b32 s46, s13, 5
    v_lshl_add_u32 v44, v4, 1, v44
    v_add_u32 v44, s46, v44
    s_lshl_b32 s46, s13, 4
    v_add_u32 v45, s46, v4
    v_lshlrev_b32 v45, 7, v45
    v_lshl_add_u32 v45, v6, 4, v45
    s_lshl_b32 s46, s62, 5
    s_add_u32 s46, s46, 31
    s_sub_u32 s46, s46, s61
    s_mul_i32 s46, s46, 8320
    s_add_u32 s46, s46, 589824
    s_lshl_b32 s63, s44, 6
    s_add_u32 s63, s63, s45
    s_lshl_b32 s63, s63, 10
    s_add_u32 s63, s63, 3145728
    s_mov_b32 s48, 0x05040100
    s_mov_b32 s49, 0x07060302
    s_waitcnt vmcnt(1) lgkmcnt(0)
    s_barrier
    s_mul_i32 s12, s12, 0x9E3779B1
    s_add_u32 s12, s12, 0x7F4A7C15
    ds_read_u16 v48, v44 offset:8960
    ds_read_u16_d16_hi v64, v44 offset:9088
    ds_read_u16 v49, v44 offset:9216
    ds_read_u16_d16_hi v65, v44 offset:9344
    ds_read_u16 v50, v44 offset:9472
    ds_read_u16_d16_hi v66, v44 offset:9600
    ds_read_u16 v51, v44 offset:9728
    ds_read_u16_d16_hi v67, v44 offset:9856
    ds_read_u16 v52, v44 offset:8976
    ds_read_u16_d16_hi v68, v44 offset:9104
    ds_read_u16 v53, v44 offset:9232
    ds_read_u16_d16_hi v69, v44 offset:9360
    ds_read_u16 v54, v44 offset:9488
    ds_read_u16_d16_hi v70, v44 offset:9616
    ds_read_u16 v55, v44 offset:9744
    ds_read_u16_d16_hi v71, v44 offset:9872
    v_lshlrev_b32 v12, 16, v12
    v_lshlrev_b32 v16, 16, v16
    v_mul_f32 v12, 0x3fb8aa3b, v12
    v_mul_f32 v16, 0x3fb8aa3b, v16
    v_exp_f32 v12, v12
    v_exp_f32 v16, v16
    v_lshlrev_b32 v13, 16, v13
    v_lshlrev_b32 v14, 16, v14
    v_lshlrev_b32_e64 v15, 16, v15
    v_cvt_pk_bf16_f32 v12, v12, v12
    v_lshlrev_b32_e64 v12, 16, v12
    v_cvt_pk_bf16_f32 v16, v16, v16
    v_lshlrev_b32 v16, 16, v16
    s_waitcnt lgkmcnt(0)
    v_or_b32 v48, v48, v64
    v_or_b32 v49, v49, v65
    v_or_b32 v50, v50, v66
    v_or_b32 v51, v51, v67
    v_or_b32 v52, v52, v68
    v_or_b32 v53, v53, v69
    v_or_b32 v54, v54, v70
    v_or_b32 v55, v55, v71
    buffer_store_dwordx4 v[48:51], v45, s[4:7], s46 offen sc1
    buffer_store_dwordx4 v[52:55], v45, s[4:7], s46 offen offset:1024 sc1
    v_mul_f32 v12, v12, v16
    v_mul_f32 v13, v13, v16
    v_mul_f32 v12, 0xbfb8aa3b, v12
    v_mul_f32 v13, 0.15915494, v13
    v_add_f32 v16, v16, v16
    v_mul_f32 v14, v14, v16
    v_mul_f32 v15, v15, v16
    v_mul_f32 v45, 0x41000000, v12
    v_mul_f32 v46, 0x41000000, v13
    v_exp_f32 v45, v45
    v_fract_f32 v46, v46
    v_cos_f32 v20, v46
    v_sin_f32 v21, v46
    v_mul_f32 v20, v45, v20
    v_mul_f32 v21, v45, v21
    v_sub_f32_e64 v22, 0, v21
    v_cvt_pk_bf16_f32 v64, 1.0, v20
    v_cvt_pk_bf16_f32 v80, 0, v21
    v_mul_f32 v47, v20, v20
    v_mul_f32 v48, v20, v21
    v_fmac_f32 v47, v21, v22
    v_fmac_f32 v48, v21, v20
    v_mul_f32 v49, v47, v20
    v_mul_f32 v50, v47, v21
    v_fmac_f32 v49, v48, v22
    v_fmac_f32 v50, v48, v20
    v_cvt_pk_bf16_f32 v65, v47, v49
    v_cvt_pk_bf16_f32 v81, v48, v50
    v_mul_f32 v47, v49, v20
    v_mul_f32 v48, v49, v21
    v_fmac_f32 v47, v50, v22
    v_fmac_f32 v48, v50, v20
    v_mul_f32 v49, v47, v20
    v_mul_f32 v50, v47, v21
    v_fmac_f32 v49, v48, v22
    v_fmac_f32 v50, v48, v20
    v_cvt_pk_bf16_f32 v66, v47, v49
    v_cvt_pk_bf16_f32 v82, v48, v50
    v_mul_f32 v47, v49, v20
    v_mul_f32 v48, v49, v21
    v_fmac_f32 v47, v50, v22
    v_fmac_f32 v48, v50, v20
    v_mul_f32 v49, v47, v20
    v_mul_f32 v50, v47, v21
    v_fmac_f32 v49, v48, v22
    v_fmac_f32 v50, v48, v20
    v_cvt_pk_bf16_f32 v67, v47, v49
    v_cvt_pk_bf16_f32 v83, v48, v50
    v_mul_f32 v47, v49, v20
    v_mul_f32 v48, v49, v21
    v_fmac_f32 v47, v50, v22
    v_fmac_f32 v48, v50, v20
    v_mul_f32 v49, v47, v20
    v_mul_f32 v50, v47, v21
    v_fmac_f32 v49, v48, v22
    v_fmac_f32 v50, v48, v20
    v_cvt_pk_bf16_f32 v68, v47, v49
    v_cvt_pk_bf16_f32 v84, v48, v50
    v_mul_f32 v47, v49, v20
    v_mul_f32 v48, v49, v21
    v_fmac_f32 v47, v50, v22
    v_fmac_f32 v48, v50, v20
    v_mul_f32 v49, v47, v20
    v_mul_f32 v50, v47, v21
    v_fmac_f32 v49, v48, v22
    v_fmac_f32 v50, v48, v20
    v_cvt_pk_bf16_f32 v69, v47, v49
    v_cvt_pk_bf16_f32 v85, v48, v50
    v_mul_f32 v47, v49, v20
    v_mul_f32 v48, v49, v21
    v_fmac_f32 v47, v50, v22
    v_fmac_f32 v48, v50, v20
    v_mul_f32 v49, v47, v20
    v_mul_f32 v50, v47, v21
    v_fmac_f32 v49, v48, v22
    v_fmac_f32 v50, v48, v20
    v_cvt_pk_bf16_f32 v70, v47, v49
    v_cvt_pk_bf16_f32 v86, v48, v50
    v_mul_f32 v47, v49, v20
    v_mul_f32 v48, v49, v21
    v_fmac_f32 v47, v50, v22
    v_fmac_f32 v48, v50, v20
    v_mul_f32 v49, v47, v20
    v_mul_f32 v50, v47, v21
    v_fmac_f32 v49, v48, v22
    v_fmac_f32 v50, v48, v20
    v_cvt_pk_bf16_f32 v71, v47, v49
    v_cvt_pk_bf16_f32 v87, v48, v50
    v_mul_f32 v47, v49, v20
    v_mul_f32 v48, v49, v21
    v_fmac_f32 v47, v50, v22
    v_fmac_f32 v48, v50, v20
    v_mul_f32 v49, v47, v20
    v_mul_f32 v50, v47, v21
    v_fmac_f32 v49, v48, v22
    v_fmac_f32 v50, v48, v20
    v_cvt_pk_bf16_f32 v72, v47, v49
    v_cvt_pk_bf16_f32 v88, v48, v50
    v_mul_f32 v47, v49, v20
    v_mul_f32 v48, v49, v21
    v_fmac_f32 v47, v50, v22
    v_fmac_f32 v48, v50, v20
    v_mul_f32 v49, v47, v20
    v_mul_f32 v50, v47, v21
    v_fmac_f32 v49, v48, v22
    v_fmac_f32 v50, v48, v20
    v_cvt_pk_bf16_f32 v73, v47, v49
    v_cvt_pk_bf16_f32 v89, v48, v50
    v_mul_f32 v47, v49, v20
    v_mul_f32 v48, v49, v21
    v_fmac_f32 v47, v50, v22
    v_fmac_f32 v48, v50, v20
    v_mul_f32 v49, v47, v20
    v_mul_f32 v50, v47, v21
    v_fmac_f32 v49, v48, v22
    v_fmac_f32 v50, v48, v20
    v_cvt_pk_bf16_f32 v74, v47, v49
    v_cvt_pk_bf16_f32 v90, v48, v50
    v_mul_f32 v47, v49, v20
    v_mul_f32 v48, v49, v21
    v_fmac_f32 v47, v50, v22
    v_fmac_f32 v48, v50, v20
    v_mul_f32 v49, v47, v20
    v_mul_f32 v50, v47, v21
    v_fmac_f32 v49, v48, v22
    v_fmac_f32 v50, v48, v20
    v_cvt_pk_bf16_f32 v75, v47, v49
    v_cvt_pk_bf16_f32 v91, v48, v50
    v_mul_f32 v47, v49, v20
    v_mul_f32 v48, v49, v21
    v_fmac_f32 v47, v50, v22
    v_fmac_f32 v48, v50, v20
    v_mul_f32 v49, v47, v20
    v_mul_f32 v50, v47, v21
    v_fmac_f32 v49, v48, v22
    v_fmac_f32 v50, v48, v20
    v_cvt_pk_bf16_f32 v76, v47, v49
    v_cvt_pk_bf16_f32 v92, v48, v50
    v_mul_f32 v47, v49, v20
    v_mul_f32 v48, v49, v21
    v_fmac_f32 v47, v50, v22
    v_fmac_f32 v48, v50, v20
    v_mul_f32 v49, v47, v20
    v_mul_f32 v50, v47, v21
    v_fmac_f32 v49, v48, v22
    v_fmac_f32 v50, v48, v20
    v_cvt_pk_bf16_f32 v77, v47, v49
    v_cvt_pk_bf16_f32 v93, v48, v50
    v_mul_f32 v47, v49, v20
    v_mul_f32 v48, v49, v21
    v_fmac_f32 v47, v50, v22
    v_fmac_f32 v48, v50, v20
    v_mul_f32 v49, v47, v20
    v_mul_f32 v50, v47, v21
    v_fmac_f32 v49, v48, v22
    v_fmac_f32 v50, v48, v20
    v_cvt_pk_bf16_f32 v78, v47, v49
    v_cvt_pk_bf16_f32 v94, v48, v50
    v_mul_f32 v47, v49, v20
    v_mul_f32 v48, v49, v21
    v_fmac_f32 v47, v50, v22
    v_fmac_f32 v48, v50, v20
    v_mul_f32 v49, v47, v20
    v_mul_f32 v50, v47, v21
    v_fmac_f32 v49, v48, v22
    v_fmac_f32 v50, v48, v20
    v_cvt_pk_bf16_f32 v79, v47, v49
    v_cvt_pk_bf16_f32 v95, v48, v50
    s_waitcnt vmcnt(0)
    s_barrier
    v_lshlrev_b32_e64 v57, 6, v7
    v_lshl_add_u32 v57, v8, 3, v57
    s_lshl_b32 s46, s13, 4
    v_add_u32 v57, s46, v57
    ds_read_b64 v[58:59], v57 offset:17408
    ds_read_b64 v[60:61], v57 offset:19456
    s_cmp_eq_u32 s13, 0
    s_cbranch_scc0 L_B_nopub
    s_lshl_b32 s46, s38, 7
    s_add_u32 s46, s46, 4096
    v_mov_b32 v62, 0
    v_mov_b32 v63, s12
    s_mov_b64 exec, 1
    buffer_store_dword v63, v62, s[4:7], s46 offen sc1
    s_mov_b64 exec, -1
L_B_nopub:
    s_waitcnt lgkmcnt(0)
    v_perm_b32 v48, v60, v58, s48
    v_perm_b32 v49, v60, v58, s49
    v_perm_b32 v50, v61, v59, s48
    v_perm_b32 v51, v61, v59, s49
    buffer_store_dwordx4 v[48:51], v10, s[4:7], s63 offen sc1
    v_mul_f32 v45, 1.0, v12
    v_mul_f32 v46, 1.0, v13
    v_exp_f32 v45, v45
    v_fract_f32 v46, v46
    v_cos_f32 v17, v46
    v_sin_f32 v18, v46
    v_mul_f32 v17, v45, v17
    v_mul_f32 v18, v45, v18
    v_sub_f32_e64 v19, 0, v18
    v_mul_f32 v45, 0x43800000, v12
    v_mul_f32 v46, 0x43800000, v13
    v_exp_f32 v45, v45
    v_fract_f32 v46, v46
    v_cos_f32 v36, v46
    v_sin_f32 v37, v46
    v_mul_f32 v36, v45, v36
    v_mul_f32 v37, v45, v37
    v_sub_f32 v38, 0, v37
    v_mul_f32 v39, v17, v17
    v_mul_f32 v40, v17, v18
    v_fmac_f32 v39, v18, v19
    v_fmac_f32 v40, v18, v17
    v_sub_f32 v41, 0, v40
    v_mul_f32 v42, v39, v39
    v_mul_f32 v43, v39, v40
    v_fmac_f32 v42, v40, v41
    v_fmac_f32 v43, v40, v39
    v_sub_f32 v44, 0, v43
    v_mul_f32 v47, v14, v17
    v_mul_f32 v48, v14, v18
    v_fmac_f32 v47, v15, v19
    v_fmac_f32_e64 v48, v15, v17
    v_cvt_pk_bf16_f32 v96, v14, v47
    v_cvt_pk_bf16_f32 v112, -v15, -v48
    v_mul_f32 v49, v47, v17
    v_mul_f32 v50, v47, v18
    v_fmac_f32 v49, v48, v19
    v_fmac_f32 v50, v48, v17
    v_mul_f32 v47, v49, v17
    v_mul_f32 v48, v49, v18
    v_fmac_f32 v47, v50, v19
    v_fmac_f32 v48, v50, v17
    v_cvt_pk_bf16_f32 v97, v49, v47
    v_cvt_pk_bf16_f32 v113, -v50, -v48
    v_mul_f32 v49, v47, v17
    v_mul_f32 v50, v47, v18
    v_fmac_f32 v49, v48, v19
    v_fmac_f32 v50, v48, v17
    v_mul_f32 v47, v49, v17
    v_mul_f32 v48, v49, v18
    v_fmac_f32 v47, v50, v19
    v_fmac_f32 v48, v50, v17
    v_cvt_pk_bf16_f32 v98, v49, v47
    v_cvt_pk_bf16_f32 v114, -v50, -v48
    v_mul_f32 v49, v47, v17
    v_mul_f32 v50, v47, v18
    v_fmac_f32 v49, v48, v19
    v_fmac_f32 v50, v48, v17
    v_mul_f32 v47, v49, v17
    v_mul_f32 v48, v49, v18
    v_fmac_f32 v47, v50, v19
    v_fmac_f32 v48, v50, v17
    v_cvt_pk_bf16_f32 v99, v49, v47
    v_cvt_pk_bf16_f32 v115, -v50, -v48
    v_mul_f32 v51, v14, v36
    v_mul_f32 v52, v14, v37
    v_fmac_f32 v51, v15, v38
    v_fmac_f32 v52, v15, v36
    v_mul_f32 v47, v51, v39
    v_mul_f32 v48, v51, v40
    v_fmac_f32 v47, v52, v41
    v_fmac_f32 v48, v52, v39
    v_cvt_pk_bf16_f32 v100, v51, v47
    v_cvt_pk_bf16_f32 v116, -v52, -v48
    v_mul_f32 v49, v47, v39
    v_mul_f32 v50, v47, v40
    v_fmac_f32 v49, v48, v41
    v_fmac_f32 v50, v48, v39
    v_mul_f32 v47, v49, v39
    v_mul_f32 v48, v49, v40
    v_fmac_f32 v47, v50, v41
    v_fmac_f32 v48, v50, v39
    v_cvt_pk_bf16_f32 v101, v49, v47
    v_cvt_pk_bf16_f32 v117, -v50, -v48
    v_mul_f32 v49, v47, v39
    v_mul_f32 v50, v47, v40
    v_fmac_f32 v49, v48, v41
    v_fmac_f32 v50, v48, v39
    v_cvt_pk_bf16_f32 v104, v49, v49
    v_cvt_pk_bf16_f32 v120, -v50, -v50
    v_mul_f32 v53, v51, v36
    v_mul_f32 v54, v51, v37
    v_fmac_f32 v53, v52, v38
    v_fmac_f32 v54, v52, v36
    v_mul_f32 v47, v53, v42
    v_mul_f32 v48, v53, v43
    v_fmac_f32 v47, v54, v44
    v_fmac_f32 v48, v54, v42
    v_cvt_pk_bf16_f32 v102, v53, v47
    v_cvt_pk_bf16_f32 v118, -v54, -v48
    v_mul_f32 v55, v47, v42
    v_mul_f32 v56, v47, v43
    v_fmac_f32 v55, v48, v44
    v_fmac_f32 v56, v48, v42
    v_mul_f32 v51, v53, v36
    v_mul_f32 v52, v53, v37
    v_fmac_f32 v51, v54, v38
    v_fmac_f32 v52, v54, v36
    v_cvt_pk_bf16_f32 v103, v55, v51
    v_cvt_pk_bf16_f32 v119, -v56, -v52
    v_mul_f32 v47, v51, v42
    v_mul_f32 v48, v51, v43
    v_fmac_f32 v47, v52, v44
    v_fmac_f32 v48, v52, v42
    v_mul_f32 v49, v47, v42
    v_mul_f32 v50, v47, v43
    v_fmac_f32 v49, v48, v44
    v_fmac_f32 v50, v48, v42
    v_cvt_pk_bf16_f32 v106, v47, v49
    v_cvt_pk_bf16_f32 v122, -v48, -v50
    v_mul_f32 v53, v51, v36
    v_mul_f32 v54, v51, v37
    v_fmac_f32 v53, v52, v38
    v_fmac_f32 v54, v52, v36
    v_mul_f32 v47, v53, v20
    v_mul_f32 v48, v53, v21
    v_fmac_f32 v47, v54, v22
    v_fmac_f32 v48, v54, v20
    v_cvt_pk_bf16_f32 v105, v53, v47
    v_cvt_pk_bf16_f32 v121, -v54, -v48
    v_mul_f32 v51, v53, v36
    v_mul_f32 v52, v53, v37
    v_fmac_f32 v51, v54, v38
    v_fmac_f32 v52, v54, v36
    v_mul_f32 v47, v51, v20
    v_mul_f32 v48, v51, v21
    v_fmac_f32 v47, v52, v22
    v_fmac_f32 v48, v52, v20
    v_cvt_pk_bf16_f32 v108, v51, v47
    v_cvt_pk_bf16_f32 v124, -v52, -v48
    v_mul_f32 v53, v51, v36
    v_mul_f32 v54, v51, v37
    v_fmac_f32 v53, v52, v38
    v_fmac_f32 v54, v52, v36
    v_mul_f32 v47, v53, v20
    v_mul_f32 v48, v53, v21
    v_fmac_f32 v47, v54, v22
    v_fmac_f32 v48, v54, v20
    v_cvt_pk_bf16_f32 v107, v53, v47
    v_cvt_pk_bf16_f32 v123, -v54, -v48
    v_mul_f32 v51, v53, v36
    v_mul_f32 v52, v53, v37
    v_fmac_f32 v51, v54, v38
    v_fmac_f32 v52, v54, v36
    v_mul_f32 v47, v51, v20
    v_mul_f32 v48, v51, v21
    v_fmac_f32 v47, v52, v22
    v_fmac_f32 v48, v52, v20
    v_cvt_pk_bf16_f32 v110, v51, v47
    v_cvt_pk_bf16_f32 v126, -v52, -v48
    v_mov_b32 v109, 0
    v_mov_b32 v125, 0
    v_mov_b32 v111, 0
    v_mov_b32_e64 v127, 0
    s_waitcnt vmcnt(0) lgkmcnt(0)
    s_barrier
    s_cmp_eq_u32 s13, 0
    s_cbranch_scc0 L_B_nog
    s_lshl_b32 s59, s38, 7
    s_add_u32 s59, s59, 458752
    v_mov_b32 v40, 0
    v_mov_b32_e64 v41, s12
    s_mov_b64 exec, 1
    buffer_store_dword v41, v40, s[4:7], s59 offen sc1
    s_mov_b64 exec, -1
L_B_nog:
    s_lshl_b32 s59, s13, 6
    s_lshl_b32 s60, s14, 3
    s_add_u32 s59, s59, s60
    v_add_u32 v46, s59, v6
    v_lshlrev_b32 v46, 7, v46
    s_mov_b32 s52, 4096
    buffer_load_dword v47, v46, s[4:7], s52 offen sc1
    s_mul_i32 s46, s13, 9216
    s_add_u32 s46, s46, 44800
    v_mul_u32_u24 v34, 144, v1
    v_add_u32 v34, s46, v34
    v_lshrrev_b32 v35, 4, v1
    v_lshrrev_b32 v24, 1, v35
    v_and_b32 v35, 1, v35
    v_bfe_u32 v25, v1, 2, 2
    v_lshrrev_b32_e64 v26, 1, v25
    v_lshl_add_u32 v26, v24, 2, v26
    v_mul_u32_u24 v26, 144, v26
    v_and_b32_e64 v25, 1, v25
    v_lshl_add_u32 v26, v25, 6, v26
    v_lshl_add_u32 v26, v35, 5, v26
    v_and_b32_e64 v25, 3, v1
    v_lshl_add_u32 v26, v25, 3, v26
    v_add_u32_e64 v35, s46, v26
    ds_write_b128 v34, v[64:67] offset:0
    ds_write_b128 v34, v[68:71] offset:16
    ds_write_b128 v34, v[72:75] offset:32
    ds_write_b128 v34, v[76:79] offset:48
    ds_write_b128 v34, v[80:83] offset:64
    ds_write_b128 v34, v[84:87] offset:80
    ds_write_b128 v34, v[88:91] offset:96
    ds_write_b128 v34, v[92:95] offset:112
    s_lshl_b32 s46, s40, 6
    v_add_u32 v48, s46, v1
    v_add_u32 v49, 128, v48
    v_min_u32 v49, 254, v49
    v_lshrrev_b32_e64 v54, 3, v48
    v_mul_u32_u24 v54, 8320, v54
    v_and_b32_e64 v50, 7, v48
    v_lshl_add_u32 v50, v50, 4, v54
    v_add_u32 v55, 1, v48
    v_lshrrev_b32 v54, 3, v55
    v_mul_u32_u24 v54, 8320, v54
    v_and_b32_e64 v51, 7, v55
    v_lshl_add_u32 v51, v51, 4, v54
    v_lshrrev_b32_e64 v54, 3, v49
    v_mul_u32_u24 v54, 8320, v54
    v_and_b32_e64 v52, 7, v49
    v_lshl_add_u32 v52, v52, 4, v54
    v_add_u32 v55, 1, v49
    v_lshrrev_b32 v54, 3, v55
    v_mul_u32_u24 v54, 8320, v54
    v_and_b32_e64 v53, 7, v55
    v_lshl_add_u32 v53, v53, 4, v54
    s_lshl_b32 s53, s14, 5
    s_mul_i32 s53, s53, 8320
    s_and_b32 s3, s41, 63
    s_lshl_b32 s3, s3, 7
    s_add_u32 s53, s53, s3
    s_add_u32 s53, s53, 589824
    v_bfe_u32 v57, v1, 3, 2
    v_mul_u32_u24 v58, 2048, v8
    v_add_u32 v58, v58, v6
    v_sub_u32 v58, v58, v57
    v_add_u32 v58, -1, v58
    v_lshrrev_b32 v59, 6, v58
    v_mul_u32_u24 v59, 8320, v59
    v_and_b32_e64 v60, 63, v58
    v_lshl_add_u32 v59, v60, 1, v59
    s_waitcnt lgkmcnt(0)
    v_mov_b32 v84, 0
    ds_read_b64_tr_b16 a[0:1], v35 offset:0
    ds_read_b64_tr_b16 a[2:3], v35 offset:288
    ds_read_b64_tr_b16 a[4:5], v35 offset:1152
    ds_read_b64_tr_b16 a[6:7], v35 offset:1440
    ds_read_b64_tr_b16 a[8:9], v35 offset:2304
    ds_read_b64_tr_b16 a[10:11], v35 offset:2592
    ds_read_b64_tr_b16 a[12:13], v35 offset:3456
    ds_read_b64_tr_b16 a[14:15], v35 offset:3744
    ds_read_b64_tr_b16 a[16:17], v35 offset:4608
    ds_read_b64_tr_b16 a[18:19], v35 offset:4896
    ds_read_b64_tr_b16 a[20:21], v35 offset:5760
    ds_read_b64_tr_b16 a[22:23], v35 offset:6048
    ds_read_b64_tr_b16 a[24:25], v35 offset:6912
    ds_read_b64_tr_b16 a[26:27], v35 offset:7200
    ds_read_b64_tr_b16 a[28:29], v35 offset:8064
    ds_read_b64_tr_b16 a[30:31], v35 offset:8352
    s_waitcnt vmcnt(0)
    v_cmp_ne_u32 vcc, s12, v47
    s_cbranch_vccz L_B_xtok
    s_mov_b32 s99, 0
L_poll_9:
    buffer_load_dword v47, v46, s[4:7], s52 offen sc1
    s_waitcnt vmcnt(0)
    v_cmp_ne_u32_e64 vcc, s12, v47
    s_cbranch_vccz L_polld_10
    s_sleep 3
    s_add_u32 s99, s99, 1
    s_cmp_lt_u32 s99, 20000
    s_cbranch_scc1 L_poll_9
L_polld_10:
L_B_xtok:
    s_barrier
    buffer_load_dwordx4 v[64:67], v50, s[4:7], s53 offen sc1
    buffer_load_dwordx4 v[68:71], v51, s[4:7], s53 offen sc1
    buffer_load_dwordx4 v[72:75], v52, s[4:7], s53 offen sc1
    buffer_load_dwordx4 v[76:79], v53, s[4:7], s53 offen sc1
    v_cmp_gt_u32 vcc, 2048, v58
    s_nop 0
    s_and_saveexec_b64 s[50:51], vcc
    buffer_load_ushort v84, v59, s[4:7], s53 offen sc1
    s_mov_b64 exec, s[50:51]
    s_waitcnt lgkmcnt(0)
    ds_write_b128 v34, v[96:99] offset:0
    ds_write_b128 v34, v[100:103] offset:16
    ds_write_b128 v34, v[104:107] offset:32
    ds_write_b128 v34, v[108:111] offset:48
    ds_write_b128 v34, v[112:115] offset:64
    ds_write_b128 v34, v[116:119] offset:80
    ds_write_b128 v34, v[120:123] offset:96
    ds_write_b128 v34, v[124:127] offset:112
    s_waitcnt lgkmcnt(0)
    ds_read_b64_tr_b16 a[32:33], v35 offset:0
    ds_read_b64_tr_b16 a[34:35], v35 offset:288
    ds_read_b64_tr_b16 a[36:37], v35 offset:1152
    ds_read_b64_tr_b16 a[38:39], v35 offset:1440
    ds_read_b64_tr_b16 a[40:41], v35 offset:2304
    ds_read_b64_tr_b16 a[42:43], v35 offset:2592
    ds_read_b64_tr_b16 a[44:45], v35 offset:3456
    ds_read_b64_tr_b16 a[46:47], v35 offset:3744
    ds_read_b64_tr_b16 a[48:49], v35 offset:4608
    ds_read_b64_tr_b16 a[50:51], v35 offset:4896
    ds_read_b64_tr_b16 a[52:53], v35 offset:5760
    ds_read_b64_tr_b16 a[54:55], v35 offset:6048
    ds_read_b64_tr_b16 a[56:57], v35 offset:6912
    ds_read_b64_tr_b16 a[58:59], v35 offset:7200
    ds_read_b64_tr_b16 a[60:61], v35 offset:8064
    ds_read_b64_tr_b16 a[62:63], v35 offset:8352
    s_waitcnt lgkmcnt(0)
    v_mfma_f32_32x32x16_bf16 v[96:111], a[32:35], a[0:3], 0
    v_mfma_f32_32x32x16_bf16 v[96:111], a[36:39], a[4:7], v[96:111]
    v_mfma_f32_32x32x16_bf16 v[96:111], a[40:43], a[8:11], v[96:111]
    v_mfma_f32_32x32x16_bf16 v[96:111], a[44:47], a[12:15], v[96:111]
    v_mfma_f32_32x32x16_bf16 v[96:111], a[48:51], a[16:19], v[96:111]
    v_mfma_f32_32x32x16_bf16 v[96:111], a[52:55], a[20:23], v[96:111]
    v_mfma_f32_32x32x16_bf16 v[96:111], a[56:59], a[24:27], v[96:111]
    v_mfma_f32_32x32x16_bf16 v[96:111], a[60:63], a[28:31], v[96:111]
    v_lshlrev_b32_e64 v55, 4, v1
    s_mul_i32 s46, s13, 9216
    s_add_u32 s46, s46, 44800
    v_add_u32 v56, s46, v55
    s_xor_b32 s47, s13, 1
    s_mul_i32 s47, s47, 9216
    s_add_u32 s47, s47, 44800
    v_add_u32_e64 v61, s47, v55
    s_mul_i32 s46, s39, 17920
    s_add_u32 s46, s46, 8960
    v_add_u32 v62, 3, v48
    v_lshrrev_b32 v54, 4, v62
    v_add_u32 v62, v62, v54
    v_lshlrev_b32 v62, 4, v62
    v_add_u32 v62, s46, v62
    v_add_u32 v63, 3, v49
    v_lshrrev_b32 v54, 4, v63
    v_add_u32 v63, v63, v54
    v_lshlrev_b32 v63, 4, v63
    v_add_u32 v63, s46, v63
    ds_write_b128 v56, v[96:99] offset:0
    ds_write_b128 v56, v[100:103] offset:1024
    ds_write_b128 v56, v[104:107] offset:2048
    ds_write_b128 v56, v[108:111] offset:3072
    s_waitcnt vmcnt(1)
    v_alignbit_b32 v88, v67, v66, 16
    v_alignbit_b32 v89, v68, v67, 16
    v_alignbit_b32 v90, v69, v68, 16
    v_alignbit_b32 v91, v70, v69, 16
    ds_write_b128 v62, v[66:69] offset:13440
    v_alignbit_b32 v95, v71, v70, 16
    v_mov_b32 v92, v89
    v_mov_b32 v93, v90
    v_mov_b32 v94, v91
    ds_write_b128 v62, v[88:91] offset:8960
    v_mov_b32 v80, v67
    v_mov_b32 v81, v68
    v_mov_b32 v82, v69
    v_mov_b32 v83, v70
    ds_write_b128 v62, v[92:95] offset:0
    ds_write_b128 v62, v[80:83] offset:4480
    v_alignbit_b32 v88, v75, v74, 16
    v_alignbit_b32 v89, v76, v75, 16
    v_alignbit_b32 v90, v77, v76, 16
    v_alignbit_b32 v91, v78, v77, 16
    ds_write_b128 v63, v[74:77] offset:13440
    v_alignbit_b32 v95, v79, v78, 16
    v_mov_b32 v92, v89
    v_mov_b32 v93, v90
    v_mov_b32_e64 v94, v91
    ds_write_b128 v63, v[88:91] offset:8960
    v_mov_b32 v80, v75
    v_mov_b32 v81, v76
    v_mov_b32 v82, v77
    v_mov_b32 v83, v78
    ds_write_b128 v63, v[92:95] offset:0
    ds_write_b128 v63, v[80:83] offset:4480
    v_mul_u32_u24 v58, 4480, v57
    v_mul_u32_u24 v59, 4352, v8
    v_add_u32_e64 v58, v58, v59
    v_lshl_add_u32 v58, v6, 1, v58
    v_add_u32 v58, s46, v58
    s_waitcnt vmcnt(0)
    s_cmp_eq_u32 s40, 0
    s_cbranch_scc0 L_B_noedge
    ds_write_b16 v58, v84 offset:32
    v_mov_b32_e64 v59, 0
    v_mul_u32_u24 v58, 4480, v57
    v_lshrrev_b32_e64 v60, 1, v6
    v_lshl_add_u32 v58, v60, 2, v58
    v_add_u32_e64 v58, s46, v58
    ds_write_b32 v58, v59 offset:4400
L_B_noedge:
    s_waitcnt lgkmcnt(0)
    s_barrier
    ds_read_b128 v[64:67], v61 offset:0
    ds_read_b128 v[68:71], v61 offset:1024
    ds_read_b128 v[72:75], v61 offset:2048
    ds_read_b128 v[76:79], v61 offset:3072
    s_mul_i32 s46, s39, 4480
    v_lshlrev_b32_e64 v2, 3, v7
    v_lshl_add_u32 v2, v8, 4, v2
    v_add_u32 v2, s46, v2
    v_lshrrev_b32 v3, 3, v7
    v_and_b32_e64 v4, 7, v7
    s_mul_i32 s47, s39, 17920
    s_add_u32 s47, s47, 8960
    v_mul_u32_u24 v5, 4480, v3
    v_add_u32_e64 v5, s47, v5
    v_add_u32 v6, 4400, v5
    v_mul_u32_u24 v9, 272, v4
    v_sub_u32_e64 v5, v5, v9
    v_lshl_add_u32 v5, v8, 4, v5
    s_mov_b32 s54, 0
    s_mov_b32 s55, -1
    s_mov_b32 s56, 0xaaaaaaaa
    s_mov_b32 s57, 0xaaaaaaaa
    v_lshl_add_u32 v58, v7, 4, s46
    s_waitcnt lgkmcnt(0)
    v_add_f32 v96, v96, v64
    v_add_f32 v97, v97, v65
    v_add_f32 v98, v98, v66
    v_add_f32 v99, v99, v67
    v_add_f32 v100, v100, v68
    v_add_f32 v101, v101, v69
    v_add_f32 v102, v102, v70
    v_add_f32 v103, v103, v71
    v_add_f32 v104, v104, v72
    v_add_f32 v105, v105, v73
    v_add_f32 v106, v106, v74
    v_add_f32 v107, v107, v75
    v_add_f32 v108, v108, v76
    v_add_f32_e64 v109, v109, v77
    s_cmp_eq_u32 s40, 0
    s_cbranch_scc0 L_B_kodd
    v_cvt_pk_bf16_f32 v64, v96, v97
    v_cvt_pk_bf16_f32 v65, v98, v99
    v_lshl_add_u32 v59, v8, 3, v58
    ds_write_b64 v59, v[64:65] offset:256
    v_cndmask_b32 v66, v101, v100, s[54:55]
    v_cndmask_b32 v67, v102, v101, s[54:55]
    v_cndmask_b32 v72, v103, v102, s[54:55]
    v_cndmask_b32 v73, v104, v102, s[54:55]
    v_cvt_pk_bf16_f32 v68, v100, v100
    v_cvt_pk_bf16_f32 v69, v66, v67
    v_cvt_pk_bf16_f32 v70, v67, v67
    v_cvt_pk_bf16_f32 v71, v72, v73
    v_lshl_add_u32 v59, v8, 9, v58
    ds_write_b128 v59, v[68:71] offset:768
    v_cvt_pk_bf16_f32 v76, v103, v103
    v_cvt_pk_bf16_f32 v77, v103, v104
    v_cvt_pk_bf16_f32 v78, v104, v104
    v_cvt_pk_bf16_f32 v79, v105, v105
    s_mov_b32 exec_lo, 0
    ds_write_b128 v58, v[76:79] offset:1792
    s_mov_b32 exec_lo, -1
    s_branch L_B_kdone
L_B_kodd:
    v_lshl_add_u32 v59, v8, 10, v58
    v_cndmask_b32 v66, v106, v107, s[56:57]
    v_cvt_pk_bf16_f32 v68, v106, v106
    v_cvt_pk_bf16_f32 v70, v66, v107
    v_cvt_pk_bf16_f32 v71, v107, v107
    v_mov_b32 v69, v68
    ds_write_b128 v59, v[68:71] offset:2304
    v_cndmask_b32 v66, v108, v109, s[56:57]
    v_cvt_pk_bf16_f32 v76, v108, v108
    v_cvt_pk_bf16_f32 v78, v66, v109
    v_cvt_pk_bf16_f32 v79, v109, v109
    v_mov_b32_e64 v77, v76
    ds_write_b128 v59, v[76:79] offset:2816
L_B_kdone:
    s_waitcnt vmcnt(0) lgkmcnt(0)
    s_barrier
    s_setprio 3
    s_cmp_eq_u32 s40, 0
    s_cbranch_scc0 L_B_convodd
    ds_read_b64 v[16:17], v2 offset:0
    ds_read_b64 v[18:19], v2 offset:8
    ds_read_b128 v[24:27], v5 offset:4112
    ds_read_b64 v[20:21], v2 offset:2048
    ds_read_b64 v[22:23], v2 offset:2056
    ds_read_b128 v[28:31], v5 offset:1936
    ds_read_b64 v[32:33], v2 offset:32
    ds_read_b64 v[34:35], v2 offset:40
    ds_read_b128 v[40:43], v5 offset:4144
    ds_read_b64 v[36:37], v2 offset:2080
    ds_read_b64 v[38:39], v2 offset:2088
    ds_read_b128 v[44:47], v5 offset:1968
    s_waitcnt lgkmcnt(6)
    v_mfma_f32_32x32x16_bf16 v[64:79], v[16:19], v[24:27], 0
    ds_read_b64 v[48:49], v2 offset:64
    ds_read_b64 v[50:51], v2 offset:72
    v_mfma_f32_32x32x16_bf16 v[80:95], v[20:23], v[24:27], 0
    ds_read_b128 v[56:59], v5 offset:4176
    ds_read_b64 v[52:53], v2 offset:2112
    v_mfma_f32_32x32x16_bf16 v[80:95], v[16:19], v[28:31], v[80:95]
    ds_read_b64 v[54:55], v2 offset:2120
    ds_read_b128 v[60:63], v5 offset:2000
    s_waitcnt lgkmcnt(6)
    v_mfma_f32_32x32x16_bf16 v[64:79], v[32:35], v[40:43], v[64:79]
    ds_read_b64 v[16:17], v2 offset:96
    ds_read_b64 v[18:19], v2 offset:104
    v_mfma_f32_32x32x16_bf16 v[80:95], v[36:39], v[40:43], v[80:95]
    ds_read_b128 v[24:27], v5 offset:4208
    ds_read_b64 v[20:21], v2 offset:2144
    v_mfma_f32_32x32x16_bf16 v[80:95], v[32:35], v[44:47], v[80:95]
    ds_read_b64 v[22:23], v2 offset:2152
    ds_read_b128 v[28:31], v5 offset:2032
    s_waitcnt lgkmcnt(6)
    v_mfma_f32_32x32x16_bf16 v[64:79], v[48:51], v[56:59], v[64:79]
    ds_read_b64 v[32:33], v2 offset:128
    ds_read_b64 v[34:35], v2 offset:136
    v_mfma_f32_32x32x16_bf16 v[80:95], v[52:55], v[56:59], v[80:95]
    ds_read_b128 v[40:43], v5 offset:4240
    ds_read_b64 v[36:37], v2 offset:2176
    v_mfma_f32_32x32x16_bf16 v[80:95], v[48:51], v[60:63], v[80:95]
    ds_read_b64 v[38:39], v2 offset:2184
    ds_read_b128 v[44:47], v5 offset:2064
    s_waitcnt lgkmcnt(6)
    v_mfma_f32_32x32x16_bf16 v[64:79], v[16:19], v[24:27], v[64:79]
    ds_read_b64 v[48:49], v2 offset:160
    ds_read_b64 v[50:51], v2 offset:168
    v_mfma_f32_32x32x16_bf16 v[80:95], v[20:23], v[24:27], v[80:95]
    ds_read_b128 v[56:59], v5 offset:4272
    ds_read_b64 v[52:53], v2 offset:2208
    v_mfma_f32_32x32x16_bf16 v[80:95], v[16:19], v[28:31], v[80:95]
    ds_read_b64 v[54:55], v2 offset:2216
    ds_read_b128 v[60:63], v5 offset:2096
    s_waitcnt lgkmcnt(6)
    v_mfma_f32_32x32x16_bf16 v[64:79], v[32:35], v[40:43], v[64:79]
    ds_read_b64 v[16:17], v2 offset:192
    ds_read_b64 v[18:19], v2 offset:200
    v_mfma_f32_32x32x16_bf16 v[80:95], v[36:39], v[40:43], v[80:95]
    ds_read_b128 v[24:27], v5 offset:4304
    ds_read_b64 v[20:21], v2 offset:2240
    v_mfma_f32_32x32x16_bf16 v[80:95], v[32:35], v[44:47], v[80:95]
    ds_read_b64 v[22:23], v2 offset:2248
    ds_read_b128 v[28:31], v5 offset:2128
    s_waitcnt lgkmcnt(6)
    v_mfma_f32_32x32x16_bf16 v[64:79], v[48:51], v[56:59], v[64:79]
    ds_read_b64 v[32:33], v2 offset:224
    ds_read_b64 v[34:35], v2 offset:232
    v_mfma_f32_32x32x16_bf16 v[80:95], v[52:55], v[56:59], v[80:95]
    ds_read_b128 v[40:43], v5 offset:4352
    ds_read_b64 v[36:37], v2 offset:2272
    v_mfma_f32_32x32x16_bf16 v[80:95], v[48:51], v[60:63], v[80:95]
    ds_read_b64 v[38:39], v2 offset:2280
    ds_read_b128 v[44:47], v5 offset:2176
    s_waitcnt lgkmcnt(6)
    v_mfma_f32_32x32x16_bf16 v[64:79], v[16:19], v[24:27], v[64:79]
    ds_read_b64 v[48:49], v2 offset:256
    ds_read_b64 v[50:51], v2 offset:264
    v_mfma_f32_32x32x16_bf16 v[80:95], v[20:23], v[24:27], v[80:95]
    ds_read_b128 v[56:59], v5 offset:4384
    ds_read_b64 v[52:53], v2 offset:2304
    v_mfma_f32_32x32x16_bf16 v[80:95], v[16:19], v[28:31], v[80:95]
    ds_read_b64 v[54:55], v2 offset:2312
    ds_read_b128 v[60:63], v5 offset:2208
    s_waitcnt lgkmcnt(6)
    v_mfma_f32_32x32x16_bf16 v[64:79], v[32:35], v[40:43], v[64:79]
    ds_read_b64 v[16:17], v2 offset:288
    ds_read_b64 v[18:19], v2 offset:296
    v_mfma_f32_32x32x16_bf16 v[80:95], v[36:39], v[40:43], v[80:95]
    v_add_u32 v11, 4416, v5
    v_min_u32 v11, v11, v6
    ds_read_b128 v[24:27], v11
    ds_read_b64 v[20:21], v2 offset:2336
    v_mfma_f32_32x32x16_bf16 v[80:95], v[32:35], v[44:47], v[80:95]
    ds_read_b64 v[22:23], v2 offset:2344
    ds_read_b128 v[28:31], v5 offset:2240
    s_waitcnt lgkmcnt(6)
    v_mfma_f32_32x32x16_bf16 v[64:79], v[48:51], v[56:59], v[64:79]
    ds_read_b64 v[32:33], v2 offset:320
    ds_read_b64 v[34:35], v2 offset:328
    v_mfma_f32_32x32x16_bf16 v[80:95], v[52:55], v[56:59], v[80:95]
    v_add_u32 v10, 4448, v5
    v_min_u32 v10, v10, v6
    ds_read_b128 v[40:43], v10
    ds_read_b64 v[36:37], v2 offset:2368
    v_mfma_f32_32x32x16_bf16 v[80:95], v[48:51], v[60:63], v[80:95]
    ds_read_b64 v[38:39], v2 offset:2376
    ds_read_b128 v[44:47], v5 offset:2272
    s_waitcnt lgkmcnt(6)
    v_mfma_f32_32x32x16_bf16 v[64:79], v[16:19], v[24:27], v[64:79]
    ds_read_b64 v[48:49], v2 offset:352
    ds_read_b64 v[50:51], v2 offset:360
    v_mfma_f32_32x32x16_bf16 v[80:95], v[20:23], v[24:27], v[80:95]
    v_add_u32 v11, 4480, v5
    v_min_u32 v11, v11, v6
    ds_read_b128 v[56:59], v11
    ds_read_b64 v[52:53], v2 offset:2400
    v_mfma_f32_32x32x16_bf16 v[80:95], v[16:19], v[28:31], v[80:95]
    ds_read_b64 v[54:55], v2 offset:2408
    ds_read_b128 v[60:63], v5 offset:2304
    s_waitcnt lgkmcnt(6)
    v_mfma_f32_32x32x16_bf16 v[64:79], v[32:35], v[40:43], v[64:79]
    ds_read_b64 v[16:17], v2 offset:384
    ds_read_b64 v[18:19], v2 offset:392
    v_mfma_f32_32x32x16_bf16 v[80:95], v[36:39], v[40:43], v[80:95]
    v_add_u32 v10, 4512, v5
    v_min_u32 v10, v10, v6
    ds_read_b128 v[24:27], v10
    ds_read_b64 v[20:21], v2 offset:2432
    v_mfma_f32_32x32x16_bf16 v[80:95], v[32:35], v[44:47], v[80:95]
    ds_read_b64 v[22:23], v2 offset:2440
    ds_read_b128 v[28:31], v5 offset:2336
    s_waitcnt lgkmcnt(6)
    v_mfma_f32_32x32x16_bf16 v[64:79], v[48:51], v[56:59], v[64:79]
    ds_read_b64 v[32:33], v2 offset:416
    ds_read_b64 v[34:35], v2 offset:424
    v_mfma_f32_32x32x16_bf16 v[80:95], v[52:55], v[56:59], v[80:95]
    v_add_u32 v11, 4544, v5
    v_min_u32 v11, v11, v6
    ds_read_b128 v[40:43], v11
    ds_read_b64 v[36:37], v2 offset:2464
    v_mfma_f32_32x32x16_bf16 v[80:95], v[48:51], v[60:63], v[80:95]
    ds_read_b64 v[38:39], v2 offset:2472
    ds_read_b128 v[44:47], v5 offset:2368
    s_waitcnt lgkmcnt(6)
    v_mfma_f32_32x32x16_bf16 v[64:79], v[16:19], v[24:27], v[64:79]
    ds_read_b64 v[48:49], v2 offset:448
    ds_read_b64 v[50:51], v2 offset:456
    v_mfma_f32_32x32x16_bf16 v[80:95], v[20:23], v[24:27], v[80:95]
    v_add_u32 v10, 4576, v5
    v_min_u32 v10, v10, v6
    ds_read_b128 v[56:59], v10
    ds_read_b64 v[52:53], v2 offset:2496
    v_mfma_f32_32x32x16_bf16 v[80:95], v[16:19], v[28:31], v[80:95]
    ds_read_b64 v[54:55], v2 offset:2504
    ds_read_b128 v[60:63], v5 offset:2400
    s_waitcnt lgkmcnt(6)
    v_mfma_f32_32x32x16_bf16 v[64:79], v[32:35], v[40:43], v[64:79]
    ds_read_b64 v[16:17], v2 offset:480
    ds_read_b64 v[18:19], v2 offset:488
    v_mfma_f32_32x32x16_bf16 v[80:95], v[36:39], v[40:43], v[80:95]
    v_add_u32 v11, 4624, v5
    v_min_u32 v11, v11, v6
    ds_read_b128 v[24:27], v11
    ds_read_b64 v[20:21], v2 offset:2528
    v_mfma_f32_32x32x16_bf16 v[80:95], v[32:35], v[44:47], v[80:95]
    ds_read_b64 v[22:23], v2 offset:2536
    ds_read_b128 v[28:31], v5 offset:2448
    s_waitcnt lgkmcnt(6)
    v_mfma_f32_32x32x16_bf16 v[64:79], v[48:51], v[56:59], v[64:79]
    ds_read_b64 v[32:33], v2 offset:512
    ds_read_b64 v[34:35], v2 offset:520
    v_mfma_f32_32x32x16_bf16 v[80:95], v[52:55], v[56:59], v[80:95]
    v_add_u32 v10, 4656, v5
    v_min_u32 v10, v10, v6
    ds_read_b128 v[40:43], v10
    ds_read_b64 v[36:37], v2 offset:2560
    v_mfma_f32_32x32x16_bf16 v[80:95], v[48:51], v[60:63], v[80:95]
    ds_read_b64 v[38:39], v2 offset:2568
    ds_read_b128 v[44:47], v5 offset:2480
    s_waitcnt lgkmcnt(6)
    v_mfma_f32_32x32x16_bf16 v[64:79], v[16:19], v[24:27], v[64:79]
    ds_read_b64 v[48:49], v2 offset:544
    ds_read_b64 v[50:51], v2 offset:552
    v_mfma_f32_32x32x16_bf16 v[80:95], v[20:23], v[24:27], v[80:95]
    v_add_u32 v11, 4688, v5
    v_min_u32 v11, v11, v6
    ds_read_b128 v[56:59], v11
    ds_read_b64 v[52:53], v2 offset:2592
    v_mfma_f32_32x32x16_bf16 v[80:95], v[16:19], v[28:31], v[80:95]
    ds_read_b64 v[54:55], v2 offset:2600
    ds_read_b128 v[60:63], v5 offset:2512
    s_waitcnt lgkmcnt(6)
    v_mfma_f32_32x32x16_bf16 v[64:79], v[32:35], v[40:43], v[64:79]
    ds_read_b64 v[16:17], v2 offset:576
    ds_read_b64 v[18:19], v2 offset:584
    v_mfma_f32_32x32x16_bf16 v[80:95], v[36:39], v[40:43], v[80:95]
    v_add_u32 v10, 4720, v5
    v_min_u32 v10, v10, v6
    ds_read_b128 v[24:27], v10
    ds_read_b64 v[20:21], v2 offset:2624
    v_mfma_f32_32x32x16_bf16 v[80:95], v[32:35], v[44:47], v[80:95]
    ds_read_b64 v[22:23], v2 offset:2632
    ds_read_b128 v[28:31], v5 offset:2544
    s_waitcnt lgkmcnt(6)
    v_mfma_f32_32x32x16_bf16 v[64:79], v[48:51], v[56:59], v[64:79]
    ds_read_b64 v[32:33], v2 offset:608
    ds_read_b64 v[34:35], v2 offset:616
    v_mfma_f32_32x32x16_bf16 v[80:95], v[52:55], v[56:59], v[80:95]
    v_add_u32 v11, 4752, v5
    v_min_u32 v11, v11, v6
    ds_read_b128 v[40:43], v11
    ds_read_b64 v[36:37], v2 offset:2656
    v_mfma_f32_32x32x16_bf16 v[80:95], v[48:51], v[60:63], v[80:95]
    ds_read_b64 v[38:39], v2 offset:2664
    ds_read_b128 v[44:47], v5 offset:2576
    s_waitcnt lgkmcnt(6)
    v_mfma_f32_32x32x16_bf16 v[64:79], v[16:19], v[24:27], v[64:79]
    ds_read_b64 v[48:49], v2 offset:640
    ds_read_b64 v[50:51], v2 offset:648
    v_mfma_f32_32x32x16_bf16 v[80:95], v[20:23], v[24:27], v[80:95]
    v_add_u32 v10, 4784, v5
    v_min_u32 v10, v10, v6
    ds_read_b128 v[56:59], v10
    ds_read_b64 v[52:53], v2 offset:2688
    v_mfma_f32_32x32x16_bf16 v[80:95], v[16:19], v[28:31], v[80:95]
    ds_read_b64 v[54:55], v2 offset:2696
    ds_read_b128 v[60:63], v5 offset:2608
    s_waitcnt lgkmcnt(6)
    v_mfma_f32_32x32x16_bf16 v[64:79], v[32:35], v[40:43], v[64:79]
    ds_read_b64 v[16:17], v2 offset:672
    ds_read_b64 v[18:19], v2 offset:680
    v_mfma_f32_32x32x16_bf16 v[80:95], v[36:39], v[40:43], v[80:95]
    v_add_u32 v11, 4816, v5
    v_min_u32 v11, v11, v6
    ds_read_b128 v[24:27], v11
    ds_read_b64 v[20:21], v2 offset:2720
    v_mfma_f32_32x32x16_bf16 v[80:95], v[32:35], v[44:47], v[80:95]
    ds_read_b64 v[22:23], v2 offset:2728
    ds_read_b128 v[28:31], v5 offset:2640
    s_waitcnt lgkmcnt(6)
    v_mfma_f32_32x32x16_bf16 v[64:79], v[48:51], v[56:59], v[64:79]
    ds_read_b64 v[32:33], v2 offset:704
    ds_read_b64 v[34:35], v2 offset:712
    v_mfma_f32_32x32x16_bf16 v[80:95], v[52:55], v[56:59], v[80:95]
    v_add_u32 v10, 4848, v5
    v_min_u32 v10, v10, v6
    ds_read_b128 v[40:43], v10
    ds_read_b64 v[36:37], v2 offset:2752
    v_mfma_f32_32x32x16_bf16 v[80:95], v[48:51], v[60:63], v[80:95]
    ds_read_b64 v[38:39], v2 offset:2760
    ds_read_b128 v[44:47], v5 offset:2672
    s_waitcnt lgkmcnt(6)
    v_mfma_f32_32x32x16_bf16 v[64:79], v[16:19], v[24:27], v[64:79]
    ds_read_b64 v[48:49], v2 offset:736
    ds_read_b64 v[50:51], v2 offset:744
    v_mfma_f32_32x32x16_bf16 v[80:95], v[20:23], v[24:27], v[80:95]
    v_add_u32 v11, 4896, v5
    v_min_u32 v11, v11, v6
    ds_read_b128 v[56:59], v11
    ds_read_b64 v[52:53], v2 offset:2784
    v_mfma_f32_32x32x16_bf16 v[80:95], v[16:19], v[28:31], v[80:95]
    ds_read_b64 v[54:55], v2 offset:2792
    ds_read_b128 v[60:63], v5 offset:2720
    s_waitcnt lgkmcnt(6)
    v_mfma_f32_32x32x16_bf16 v[64:79], v[32:35], v[40:43], v[64:79]
    ds_read_b64 v[16:17], v2 offset:768
    ds_read_b64 v[18:19], v2 offset:776
    v_mfma_f32_32x32x16_bf16 v[80:95], v[36:39], v[40:43], v[80:95]
    v_add_u32 v10, 4928, v5
    v_min_u32 v10, v10, v6
    ds_read_b128 v[24:27], v10
    ds_read_b64 v[20:21], v2 offset:2816
    v_mfma_f32_32x32x16_bf16 v[80:95], v[32:35], v[44:47], v[80:95]
    ds_read_b64 v[22:23], v2 offset:2824
    ds_read_b128 v[28:31], v5 offset:2752
    s_waitcnt lgkmcnt(6)
    v_mfma_f32_32x32x16_bf16 v[64:79], v[48:51], v[56:59], v[64:79]
    ds_read_b64 v[32:33], v2 offset:800
    ds_read_b64 v[34:35], v2 offset:808
    v_mfma_f32_32x32x16_bf16 v[80:95], v[52:55], v[56:59], v[80:95]
    v_add_u32 v11, 4960, v5
    v_min_u32 v11, v11, v6
    ds_read_b128 v[40:43], v11
    ds_read_b64 v[36:37], v2 offset:2848
    v_mfma_f32_32x32x16_bf16 v[80:95], v[48:51], v[60:63], v[80:95]
    ds_read_b64 v[38:39], v2 offset:2856
    ds_read_b128 v[44:47], v5 offset:2784
    s_waitcnt lgkmcnt(6)
    v_mfma_f32_32x32x16_bf16 v[64:79], v[16:19], v[24:27], v[64:79]
    ds_read_b64 v[48:49], v2 offset:832
    ds_read_b64 v[50:51], v2 offset:840
    v_mfma_f32_32x32x16_bf16 v[80:95], v[20:23], v[24:27], v[80:95]
    v_add_u32 v10, 4992, v5
    v_min_u32 v10, v10, v6
    ds_read_b128 v[56:59], v10
    ds_read_b64 v[52:53], v2 offset:2880
    v_mfma_f32_32x32x16_bf16 v[80:95], v[16:19], v[28:31], v[80:95]
    ds_read_b64 v[54:55], v2 offset:2888
    ds_read_b128 v[60:63], v5 offset:2816
    s_waitcnt lgkmcnt(6)
    v_mfma_f32_32x32x16_bf16 v[64:79], v[32:35], v[40:43], v[64:79]
    ds_read_b64 v[16:17], v2 offset:864
    ds_read_b64 v[18:19], v2 offset:872
    v_mfma_f32_32x32x16_bf16 v[80:95], v[36:39], v[40:43], v[80:95]
    v_add_u32 v11, 5024, v5
    v_min_u32 v11, v11, v6
    ds_read_b128 v[24:27], v11
    ds_read_b64 v[20:21], v2 offset:2912
    v_mfma_f32_32x32x16_bf16 v[80:95], v[32:35], v[44:47], v[80:95]
    ds_read_b64 v[22:23], v2 offset:2920
    ds_read_b128 v[28:31], v5 offset:2848
    s_waitcnt lgkmcnt(6)
    v_mfma_f32_32x32x16_bf16 v[64:79], v[48:51], v[56:59], v[64:79]
    ds_read_b64 v[32:33], v2 offset:896
    ds_read_b64 v[34:35], v2 offset:904
    v_mfma_f32_32x32x16_bf16 v[80:95], v[52:55], v[56:59], v[80:95]
    v_add_u32 v10, 5056, v5
    v_min_u32 v10, v10, v6
    ds_read_b128 v[40:43], v10
    ds_read_b64 v[36:37], v2 offset:2944
    v_mfma_f32_32x32x16_bf16 v[80:95], v[48:51], v[60:63], v[80:95]
    ds_read_b64 v[38:39], v2 offset:2952
    ds_read_b128 v[44:47], v5 offset:2880
    s_waitcnt lgkmcnt(6)
    v_mfma_f32_32x32x16_bf16 v[64:79], v[16:19], v[24:27], v[64:79]
    ds_read_b64 v[48:49], v2 offset:928
    ds_read_b64 v[50:51], v2 offset:936
    v_mfma_f32_32x32x16_bf16 v[80:95], v[20:23], v[24:27], v[80:95]
    v_add_u32 v11, 5088, v5
    v_min_u32 v11, v11, v6
    ds_read_b128 v[56:59], v11
    ds_read_b64 v[52:53], v2 offset:2976
    v_mfma_f32_32x32x16_bf16 v[80:95], v[16:19], v[28:31], v[80:95]
    ds_read_b64 v[54:55], v2 offset:2984
    ds_read_b128 v[60:63], v5 offset:2912
    s_waitcnt lgkmcnt(6)
    v_mfma_f32_32x32x16_bf16 v[64:79], v[32:35], v[40:43], v[64:79]
    ds_read_b64 v[16:17], v2 offset:960
    ds_read_b64 v[18:19], v2 offset:968
    v_mfma_f32_32x32x16_bf16 v[80:95], v[36:39], v[40:43], v[80:95]
    v_add_u32 v10, 5120, v5
    v_min_u32 v10, v10, v6
    ds_read_b128 v[24:27], v10
    ds_read_b64 v[20:21], v2 offset:3008
    v_mfma_f32_32x32x16_bf16 v[80:95], v[32:35], v[44:47], v[80:95]
    ds_read_b64 v[22:23], v2 offset:3016
    ds_read_b128 v[28:31], v5 offset:2944
    s_waitcnt lgkmcnt(6)
    v_mfma_f32_32x32x16_bf16 v[64:79], v[48:51], v[56:59], v[64:79]
    ds_read_b64 v[32:33], v2 offset:992
    ds_read_b64 v[34:35], v2 offset:1000
    v_mfma_f32_32x32x16_bf16 v[80:95], v[52:55], v[56:59], v[80:95]
    v_add_u32 v11, 5168, v5
    v_min_u32 v11, v11, v6
    ds_read_b128 v[40:43], v11
    ds_read_b64 v[36:37], v2 offset:3040
    v_mfma_f32_32x32x16_bf16 v[80:95], v[48:51], v[60:63], v[80:95]
    ds_read_b64 v[38:39], v2 offset:3048
    ds_read_b128 v[44:47], v5 offset:2992
    s_waitcnt lgkmcnt(6)
    v_mfma_f32_32x32x16_bf16 v[64:79], v[16:19], v[24:27], v[64:79]
    ds_read_b64 v[48:49], v2 offset:1024
    ds_read_b64 v[50:51], v2 offset:1032
    v_mfma_f32_32x32x16_bf16 v[80:95], v[20:23], v[24:27], v[80:95]
    v_add_u32 v10, 5200, v5
    v_min_u32 v10, v10, v6
    ds_read_b128 v[56:59], v10
    ds_read_b64 v[52:53], v2 offset:3072
    v_mfma_f32_32x32x16_bf16 v[80:95], v[16:19], v[28:31], v[80:95]
    ds_read_b64 v[54:55], v2 offset:3080
    ds_read_b128 v[60:63], v5 offset:3024
    s_waitcnt lgkmcnt(6)
    v_mfma_f32_32x32x16_bf16 v[64:79], v[32:35], v[40:43], v[64:79]
    v_mfma_f32_32x32x16_bf16 v[80:95], v[36:39], v[40:43], v[80:95]
    v_mfma_f32_32x32x16_bf16 v[80:95], v[32:35], v[44:47], v[80:95]
    s_waitcnt lgkmcnt(0)
    v_mfma_f32_32x32x16_bf16 v[64:79], v[48:51], v[56:59], v[64:79]
    v_mfma_f32_32x32x16_bf16 v[80:95], v[52:55], v[56:59], v[80:95]
    v_mfma_f32_32x32x16_bf16 v[80:95], v[48:51], v[60:63], v[80:95]
    v_lshlrev_b32 v10, 4, v1
    s_lshl_b32 s46, s13, 12
    s_add_u32 s46, s46, 44800
    v_add_u32 v11, s46, v10
    s_nop 7
    ds_write_b128 v11, v[80:83] offset:0
    ds_write_b128 v11, v[84:87] offset:1024
    ds_write_b128 v11, v[88:91] offset:2048
    ds_write_b128 v11, v[92:95] offset:3072
    s_branch L_B_convdone
L_B_convodd:
    ds_read_b64 v[16:17], v2 offset:1056
    ds_read_b64 v[18:19], v2 offset:1064
    v_add_u32 v11, 5232, v5
    v_min_u32 v11, v11, v6
    ds_read_b128 v[24:27], v11
    ds_read_b64 v[20:21], v2 offset:3104
    ds_read_b64 v[22:23], v2 offset:3112
    ds_read_b128 v[28:31], v5 offset:3056
    ds_read_b64 v[32:33], v2 offset:1088
    ds_read_b64 v[34:35], v2 offset:1096
    v_add_u32 v10, 5264, v5
    v_min_u32_e64 v10, v10, v6
    ds_read_b128 v[40:43], v10
    ds_read_b64 v[36:37], v2 offset:3136
    ds_read_b64 v[38:39], v2 offset:3144
    ds_read_b128 v[44:47], v5 offset:3088
    s_waitcnt lgkmcnt(6)
    v_mfma_f32_32x32x16_bf16 v[64:79], v[16:19], v[24:27], 0
    ds_read_b64 v[48:49], v2 offset:1120
    ds_read_b64 v[50:51], v2 offset:1128
    v_mfma_f32_32x32x16_bf16 v[80:95], v[20:23], v[24:27], 0
    v_add_u32 v11, 5296, v5
    v_min_u32 v11, v11, v6
    ds_read_b128 v[56:59], v11
    ds_read_b64 v[52:53], v2 offset:3168
    v_mfma_f32_32x32x16_bf16 v[80:95], v[16:19], v[28:31], v[80:95]
    ds_read_b64 v[54:55], v2 offset:3176
    ds_read_b128 v[60:63], v5 offset:3120
    s_waitcnt lgkmcnt(6)
    v_mfma_f32_32x32x16_bf16 v[64:79], v[32:35], v[40:43], v[64:79]
    ds_read_b64 v[16:17], v2 offset:1152
    ds_read_b64 v[18:19], v2 offset:1160
    v_mfma_f32_32x32x16_bf16 v[80:95], v[36:39], v[40:43], v[80:95]
    v_add_u32 v10, 5328, v5
    v_min_u32 v10, v10, v6
    ds_read_b128 v[24:27], v10
    ds_read_b64 v[20:21], v2 offset:3200
    v_mfma_f32_32x32x16_bf16 v[80:95], v[32:35], v[44:47], v[80:95]
    ds_read_b64 v[22:23], v2 offset:3208
    ds_read_b128 v[28:31], v5 offset:3152
    s_waitcnt lgkmcnt(6)
    v_mfma_f32_32x32x16_bf16 v[64:79], v[48:51], v[56:59], v[64:79]
    ds_read_b64 v[32:33], v2 offset:1184
    ds_read_b64 v[34:35], v2 offset:1192
    v_mfma_f32_32x32x16_bf16 v[80:95], v[52:55], v[56:59], v[80:95]
    v_add_u32 v11, 5360, v5
    v_min_u32 v11, v11, v6
    ds_read_b128 v[40:43], v11
    ds_read_b64 v[36:37], v2 offset:3232
    v_mfma_f32_32x32x16_bf16 v[80:95], v[48:51], v[60:63], v[80:95]
    ds_read_b64 v[38:39], v2 offset:3240
    ds_read_b128 v[44:47], v5 offset:3184
    s_waitcnt lgkmcnt(6)
    v_mfma_f32_32x32x16_bf16 v[64:79], v[16:19], v[24:27], v[64:79]
    ds_read_b64 v[48:49], v2 offset:1216
    ds_read_b64 v[50:51], v2 offset:1224
    v_mfma_f32_32x32x16_bf16 v[80:95], v[20:23], v[24:27], v[80:95]
    v_add_u32 v10, 5392, v5
    v_min_u32 v10, v10, v6
    ds_read_b128 v[56:59], v10
    ds_read_b64 v[52:53], v2 offset:3264
    v_mfma_f32_32x32x16_bf16 v[80:95], v[16:19], v[28:31], v[80:95]
    ds_read_b64 v[54:55], v2 offset:3272
    ds_read_b128 v[60:63], v5 offset:3216
    s_waitcnt lgkmcnt(6)
    v_mfma_f32_32x32x16_bf16 v[64:79], v[32:35], v[40:43], v[64:79]
    ds_read_b64 v[16:17], v2 offset:1248
    ds_read_b64 v[18:19], v2 offset:1256
    v_mfma_f32_32x32x16_bf16 v[80:95], v[36:39], v[40:43], v[80:95]
    v_add_u32 v11, 5440, v5
    v_min_u32 v11, v11, v6
    ds_read_b128 v[24:27], v11
    ds_read_b64 v[20:21], v2 offset:3296
    v_mfma_f32_32x32x16_bf16 v[80:95], v[32:35], v[44:47], v[80:95]
    ds_read_b64 v[22:23], v2 offset:3304
    ds_read_b128 v[28:31], v5 offset:3264
    s_waitcnt lgkmcnt(6)
    v_mfma_f32_32x32x16_bf16 v[64:79], v[48:51], v[56:59], v[64:79]
    ds_read_b64 v[32:33], v2 offset:1280
    ds_read_b64 v[34:35], v2 offset:1288
    v_mfma_f32_32x32x16_bf16 v[80:95], v[52:55], v[56:59], v[80:95]
    v_add_u32 v10, 5472, v5
    v_min_u32 v10, v10, v6
    ds_read_b128 v[40:43], v10
    ds_read_b64 v[36:37], v2 offset:3328
    v_mfma_f32_32x32x16_bf16 v[80:95], v[48:51], v[60:63], v[80:95]
    ds_read_b64 v[38:39], v2 offset:3336
    ds_read_b128 v[44:47], v5 offset:3296
    s_waitcnt lgkmcnt(6)
    v_mfma_f32_32x32x16_bf16 v[64:79], v[16:19], v[24:27], v[64:79]
    ds_read_b64 v[48:49], v2 offset:1312
    ds_read_b64 v[50:51], v2 offset:1320
    v_mfma_f32_32x32x16_bf16 v[80:95], v[20:23], v[24:27], v[80:95]
    v_add_u32 v11, 5504, v5
    v_min_u32 v11, v11, v6
    ds_read_b128 v[56:59], v11
    ds_read_b64 v[52:53], v2 offset:3360
    v_mfma_f32_32x32x16_bf16 v[80:95], v[16:19], v[28:31], v[80:95]
    ds_read_b64 v[54:55], v2 offset:3368
    ds_read_b128 v[60:63], v5 offset:3328
    s_waitcnt lgkmcnt(6)
    v_mfma_f32_32x32x16_bf16 v[64:79], v[32:35], v[40:43], v[64:79]
    ds_read_b64 v[16:17], v2 offset:1344
    ds_read_b64 v[18:19], v2 offset:1352
    v_mfma_f32_32x32x16_bf16 v[80:95], v[36:39], v[40:43], v[80:95]
    v_add_u32 v10, 5536, v5
    v_min_u32 v10, v10, v6
    ds_read_b128 v[24:27], v10
    ds_read_b64 v[20:21], v2 offset:3392
    v_mfma_f32_32x32x16_bf16 v[80:95], v[32:35], v[44:47], v[80:95]
    ds_read_b64 v[22:23], v2 offset:3400
    ds_read_b128 v[28:31], v5 offset:3360
    s_waitcnt lgkmcnt(6)
    v_mfma_f32_32x32x16_bf16 v[64:79], v[48:51], v[56:59], v[64:79]
    ds_read_b64 v[32:33], v2 offset:1376
    ds_read_b64 v[34:35], v2 offset:1384
    v_mfma_f32_32x32x16_bf16 v[80:95], v[52:55], v[56:59], v[80:95]
    v_add_u32 v11, 5568, v5
    v_min_u32 v11, v11, v6
    ds_read_b128 v[40:43], v11
    ds_read_b64 v[36:37], v2 offset:3424
    v_mfma_f32_32x32x16_bf16 v[80:95], v[48:51], v[60:63], v[80:95]
    ds_read_b64 v[38:39], v2 offset:3432
    ds_read_b128 v[44:47], v5 offset:3392
    s_waitcnt lgkmcnt(6)
    v_mfma_f32_32x32x16_bf16 v[64:79], v[16:19], v[24:27], v[64:79]
    ds_read_b64 v[48:49], v2 offset:1408
    ds_read_b64 v[50:51], v2 offset:1416
    v_mfma_f32_32x32x16_bf16 v[80:95], v[20:23], v[24:27], v[80:95]
    v_add_u32 v10, 5600, v5
    v_min_u32 v10, v10, v6
    ds_read_b128 v[56:59], v10
    ds_read_b64 v[52:53], v2 offset:3456
    v_mfma_f32_32x32x16_bf16 v[80:95], v[16:19], v[28:31], v[80:95]
    ds_read_b64 v[54:55], v2 offset:3464
    ds_read_b128 v[60:63], v5 offset:3424
    s_waitcnt lgkmcnt(6)
    v_mfma_f32_32x32x16_bf16 v[64:79], v[32:35], v[40:43], v[64:79]
    ds_read_b64 v[16:17], v2 offset:1440
    ds_read_b64 v[18:19], v2 offset:1448
    v_mfma_f32_32x32x16_bf16 v[80:95], v[36:39], v[40:43], v[80:95]
    v_add_u32 v11, 5632, v5
    v_min_u32 v11, v11, v6
    ds_read_b128 v[24:27], v11
    ds_read_b64 v[20:21], v2 offset:3488
    v_mfma_f32_32x32x16_bf16 v[80:95], v[32:35], v[44:47], v[80:95]
    ds_read_b64 v[22:23], v2 offset:3496
    ds_read_b128 v[28:31], v5 offset:3456
    s_waitcnt lgkmcnt(6)
    v_mfma_f32_32x32x16_bf16 v[64:79], v[48:51], v[56:59], v[64:79]
    ds_read_b64 v[32:33], v2 offset:1472
    ds_read_b64 v[34:35], v2 offset:1480
    v_mfma_f32_32x32x16_bf16 v[80:95], v[52:55], v[56:59], v[80:95]
    v_add_u32 v10, 5664, v5
    v_min_u32 v10, v10, v6
    ds_read_b128 v[40:43], v10
    ds_read_b64 v[36:37], v2 offset:3520
    v_mfma_f32_32x32x16_bf16 v[80:95], v[48:51], v[60:63], v[80:95]
    ds_read_b64 v[38:39], v2 offset:3528
    ds_read_b128 v[44:47], v5 offset:3488
    s_waitcnt lgkmcnt(6)
    v_mfma_f32_32x32x16_bf16 v[64:79], v[16:19], v[24:27], v[64:79]
    ds_read_b64 v[48:49], v2 offset:1504
    ds_read_b64 v[50:51], v2 offset:1512
    v_mfma_f32_32x32x16_bf16 v[80:95], v[20:23], v[24:27], v[80:95]
    v_add_u32 v11, 5712, v5
    v_min_u32 v11, v11, v6
    ds_read_b128 v[56:59], v11
    ds_read_b64 v[52:53], v2 offset:3552
    v_mfma_f32_32x32x16_bf16 v[80:95], v[16:19], v[28:31], v[80:95]
    ds_read_b64 v[54:55], v2 offset:3560
    ds_read_b128 v[60:63], v5 offset:3536
    s_waitcnt lgkmcnt(6)
    v_mfma_f32_32x32x16_bf16 v[64:79], v[32:35], v[40:43], v[64:79]
    ds_read_b64 v[16:17], v2 offset:1536
    ds_read_b64 v[18:19], v2 offset:1544
    v_mfma_f32_32x32x16_bf16 v[80:95], v[36:39], v[40:43], v[80:95]
    v_add_u32 v10, 5744, v5
    v_min_u32 v10, v10, v6
    ds_read_b128 v[24:27], v10
    ds_read_b64 v[20:21], v2 offset:3584
    v_mfma_f32_32x32x16_bf16 v[80:95], v[32:35], v[44:47], v[80:95]
    ds_read_b64 v[22:23], v2 offset:3592
    ds_read_b128 v[28:31], v5 offset:3568
    s_waitcnt lgkmcnt(6)
    v_mfma_f32_32x32x16_bf16 v[64:79], v[48:51], v[56:59], v[64:79]
    ds_read_b64 v[32:33], v2 offset:1568
    ds_read_b64 v[34:35], v2 offset:1576
    v_mfma_f32_32x32x16_bf16 v[80:95], v[52:55], v[56:59], v[80:95]
    v_add_u32 v11, 5776, v5
    v_min_u32 v11, v11, v6
    ds_read_b128 v[40:43], v11
    ds_read_b64 v[36:37], v2 offset:3616
    v_mfma_f32_32x32x16_bf16 v[80:95], v[48:51], v[60:63], v[80:95]
    ds_read_b64 v[38:39], v2 offset:3624
    ds_read_b128 v[44:47], v5 offset:3600
    s_waitcnt lgkmcnt(6)
    v_mfma_f32_32x32x16_bf16 v[64:79], v[16:19], v[24:27], v[64:79]
    ds_read_b64 v[48:49], v2 offset:1600
    ds_read_b64 v[50:51], v2 offset:1608
    v_mfma_f32_32x32x16_bf16 v[80:95], v[20:23], v[24:27], v[80:95]
    v_add_u32 v10, 5808, v5
    v_min_u32 v10, v10, v6
    ds_read_b128 v[56:59], v10
    ds_read_b64 v[52:53], v2 offset:3648
    v_mfma_f32_32x32x16_bf16 v[80:95], v[16:19], v[28:31], v[80:95]
    ds_read_b64 v[54:55], v2 offset:3656
    ds_read_b128 v[60:63], v5 offset:3632
    s_waitcnt lgkmcnt(6)
    v_mfma_f32_32x32x16_bf16 v[64:79], v[32:35], v[40:43], v[64:79]
    ds_read_b64 v[16:17], v2 offset:1632
    ds_read_b64 v[18:19], v2 offset:1640
    v_mfma_f32_32x32x16_bf16 v[80:95], v[36:39], v[40:43], v[80:95]
    v_add_u32 v11, 5840, v5
    v_min_u32 v11, v11, v6
    ds_read_b128 v[24:27], v11
    ds_read_b64 v[20:21], v2 offset:3680
    v_mfma_f32_32x32x16_bf16 v[80:95], v[32:35], v[44:47], v[80:95]
    ds_read_b64 v[22:23], v2 offset:3688
    ds_read_b128 v[28:31], v5 offset:3664
    s_waitcnt lgkmcnt(6)
    v_mfma_f32_32x32x16_bf16 v[64:79], v[48:51], v[56:59], v[64:79]
    ds_read_b64 v[32:33], v2 offset:1664
    ds_read_b64 v[34:35], v2 offset:1672
    v_mfma_f32_32x32x16_bf16 v[80:95], v[52:55], v[56:59], v[80:95]
    v_add_u32 v10, 5872, v5
    v_min_u32 v10, v10, v6
    ds_read_b128 v[40:43], v10
    ds_read_b64 v[36:37], v2 offset:3712
    v_mfma_f32_32x32x16_bf16 v[80:95], v[48:51], v[60:63], v[80:95]
    ds_read_b64 v[38:39], v2 offset:3720
    ds_read_b128 v[44:47], v5 offset:3696
    s_waitcnt lgkmcnt(6)
    v_mfma_f32_32x32x16_bf16 v[64:79], v[16:19], v[24:27], v[64:79]
    ds_read_b64 v[48:49], v2 offset:1696
    ds_read_b64 v[50:51], v2 offset:1704
    v_mfma_f32_32x32x16_bf16 v[80:95], v[20:23], v[24:27], v[80:95]
    v_add_u32 v11, 5904, v5
    v_min_u32 v11, v11, v6
    ds_read_b128 v[56:59], v11
    ds_read_b64 v[52:53], v2 offset:3744
    v_mfma_f32_32x32x16_bf16 v[80:95], v[16:19], v[28:31], v[80:95]
    ds_read_b64 v[54:55], v2 offset:3752
    ds_read_b128 v[60:63], v5 offset:3728
    s_waitcnt lgkmcnt(6)
    v_mfma_f32_32x32x16_bf16 v[64:79], v[32:35], v[40:43], v[64:79]
    ds_read_b64 v[16:17], v2 offset:1728
    ds_read_b64 v[18:19], v2 offset:1736
    v_mfma_f32_32x32x16_bf16 v[80:95], v[36:39], v[40:43], v[80:95]
    v_add_u32 v10, 5936, v5
    v_min_u32 v10, v10, v6
    ds_read_b128 v[24:27], v10
    ds_read_b64 v[20:21], v2 offset:3776
    v_mfma_f32_32x32x16_bf16 v[80:95], v[32:35], v[44:47], v[80:95]
    ds_read_b64 v[22:23], v2 offset:3784
    ds_read_b128 v[28:31], v5 offset:3760
    s_waitcnt lgkmcnt(6)
    v_mfma_f32_32x32x16_bf16 v[64:79], v[48:51], v[56:59], v[64:79]
    ds_read_b64 v[32:33], v2 offset:1760
    ds_read_b64 v[34:35], v2 offset:1768
    v_mfma_f32_32x32x16_bf16 v[80:95], v[52:55], v[56:59], v[80:95]
    v_add_u32 v11, 5984, v5
    v_min_u32 v11, v11, v6
    ds_read_b128 v[40:43], v11
    ds_read_b64 v[36:37], v2 offset:3808
    v_mfma_f32_32x32x16_bf16 v[80:95], v[48:51], v[60:63], v[80:95]
    ds_read_b64 v[38:39], v2 offset:3816
    ds_read_b128 v[44:47], v5 offset:3808
    s_waitcnt lgkmcnt(6)
    v_mfma_f32_32x32x16_bf16 v[64:79], v[16:19], v[24:27], v[64:79]
    ds_read_b64 v[48:49], v2 offset:1792
    ds_read_b64 v[50:51], v2 offset:1800
    v_mfma_f32_32x32x16_bf16 v[80:95], v[20:23], v[24:27], v[80:95]
    v_add_u32 v10, 6016, v5
    v_min_u32 v10, v10, v6
    ds_read_b128 v[56:59], v10
    ds_read_b64 v[52:53], v2 offset:3840
    v_mfma_f32_32x32x16_bf16 v[80:95], v[16:19], v[28:31], v[80:95]
    ds_read_b64 v[54:55], v2 offset:3848
    ds_read_b128 v[60:63], v5 offset:3840
    s_waitcnt lgkmcnt(6)
    v_mfma_f32_32x32x16_bf16 v[64:79], v[32:35], v[40:43], v[64:79]
    ds_read_b64 v[16:17], v2 offset:1824
    ds_read_b64 v[18:19], v2 offset:1832
    v_mfma_f32_32x32x16_bf16 v[80:95], v[36:39], v[40:43], v[80:95]
    v_add_u32 v11, 6048, v5
    v_min_u32 v11, v11, v6
    ds_read_b128 v[24:27], v11
    ds_read_b64 v[20:21], v2 offset:3872
    v_mfma_f32_32x32x16_bf16 v[80:95], v[32:35], v[44:47], v[80:95]
    ds_read_b64 v[22:23], v2 offset:3880
    ds_read_b128 v[28:31], v5 offset:3872
    s_waitcnt lgkmcnt(6)
    v_mfma_f32_32x32x16_bf16 v[64:79], v[48:51], v[56:59], v[64:79]
    ds_read_b64 v[32:33], v2 offset:1856
    ds_read_b64 v[34:35], v2 offset:1864
    v_mfma_f32_32x32x16_bf16 v[80:95], v[52:55], v[56:59], v[80:95]
    v_add_u32 v10, 6080, v5
    v_min_u32 v10, v10, v6
    ds_read_b128 v[40:43], v10
    ds_read_b64 v[36:37], v2 offset:3904
    v_mfma_f32_32x32x16_bf16 v[80:95], v[48:51], v[60:63], v[80:95]
    ds_read_b64 v[38:39], v2 offset:3912
    ds_read_b128 v[44:47], v5 offset:3904
    s_waitcnt lgkmcnt(6)
    v_mfma_f32_32x32x16_bf16 v[64:79], v[16:19], v[24:27], v[64:79]
    ds_read_b64 v[48:49], v2 offset:1888
    ds_read_b64 v[50:51], v2 offset:1896
    v_mfma_f32_32x32x16_bf16 v[80:95], v[20:23], v[24:27], v[80:95]
    v_add_u32 v11, 6112, v5
    v_min_u32 v11, v11, v6
    ds_read_b128 v[56:59], v11
    ds_read_b64 v[52:53], v2 offset:3936
    v_mfma_f32_32x32x16_bf16 v[80:95], v[16:19], v[28:31], v[80:95]
    ds_read_b64 v[54:55], v2 offset:3944
    ds_read_b128 v[60:63], v5 offset:3936
    s_waitcnt lgkmcnt(6)
    v_mfma_f32_32x32x16_bf16 v[64:79], v[32:35], v[40:43], v[64:79]
    ds_read_b64 v[16:17], v2 offset:1920
    ds_read_b64 v[18:19], v2 offset:1928
    v_mfma_f32_32x32x16_bf16 v[80:95], v[36:39], v[40:43], v[80:95]
    v_add_u32 v10, 6144, v5
    v_min_u32 v10, v10, v6
    ds_read_b128 v[24:27], v10
    ds_read_b64 v[20:21], v2 offset:3968
    v_mfma_f32_32x32x16_bf16 v[80:95], v[32:35], v[44:47], v[80:95]
    ds_read_b64 v[22:23], v2 offset:3976
    ds_read_b128 v[28:31], v5 offset:3968
    s_waitcnt lgkmcnt(6)
    v_mfma_f32_32x32x16_bf16 v[64:79], v[48:51], v[56:59], v[64:79]
    ds_read_b64 v[32:33], v2 offset:1952
    ds_read_b64 v[34:35], v2 offset:1960
    v_mfma_f32_32x32x16_bf16 v[80:95], v[52:55], v[56:59], v[80:95]
    v_add_u32 v11, 6176, v5
    v_min_u32 v11, v11, v6
    ds_read_b128 v[40:43], v11
    ds_read_b64 v[36:37], v2 offset:4000
    v_mfma_f32_32x32x16_bf16 v[80:95], v[48:51], v[60:63], v[80:95]
    ds_read_b64 v[38:39], v2 offset:4008
    ds_read_b128 v[44:47], v5 offset:4000
    s_waitcnt lgkmcnt(6)
    v_mfma_f32_32x32x16_bf16 v[64:79], v[16:19], v[24:27], v[64:79]
    ds_read_b64 v[48:49], v2 offset:1984
    ds_read_b64 v[50:51], v2 offset:1992
    v_mfma_f32_32x32x16_bf16 v[80:95], v[20:23], v[24:27], v[80:95]
    v_add_u32 v10, 6208, v5
    v_min_u32 v10, v10, v6
    ds_read_b128 v[56:59], v10
    ds_read_b64 v[52:53], v2 offset:4032
    v_mfma_f32_32x32x16_bf16 v[80:95], v[16:19], v[28:31], v[80:95]
    ds_read_b64 v[54:55], v2 offset:4040
    ds_read_b128 v[60:63], v5 offset:4032
    s_waitcnt lgkmcnt(6)
    v_mfma_f32_32x32x16_bf16 v[64:79], v[32:35], v[40:43], v[64:79]
    ds_read_b64 v[16:17], v2 offset:2016
    ds_read_b64 v[18:19], v2 offset:2024
    v_mfma_f32_32x32x16_bf16 v[80:95], v[36:39], v[40:43], v[80:95]
    v_add_u32 v11, 6256, v5
    v_min_u32 v11, v11, v6
    ds_read_b128 v[24:27], v11
    ds_read_b64 v[20:21], v2 offset:4064
    v_mfma_f32_32x32x16_bf16 v[80:95], v[32:35], v[44:47], v[80:95]
    ds_read_b64 v[22:23], v2 offset:4072
    ds_read_b128 v[28:31], v5 offset:4080
    s_waitcnt lgkmcnt(6)
    v_mfma_f32_32x32x16_bf16 v[64:79], v[48:51], v[56:59], v[64:79]
    ds_read_b64 v[32:33], v2 offset:2048
    ds_read_b64 v[34:35], v2 offset:2056
    v_mfma_f32_32x32x16_bf16 v[80:95], v[52:55], v[56:59], v[80:95]
    v_add_u32 v10, 6288, v5
    v_min_u32 v10, v10, v6
    ds_read_b128 v[40:43], v10
    ds_read_b64 v[36:37], v2 offset:4096
    v_mfma_f32_32x32x16_bf16 v[80:95], v[48:51], v[60:63], v[80:95]
    ds_read_b64 v[38:39], v2 offset:4104
    s_waitcnt lgkmcnt(5)
    v_mfma_f32_32x32x16_bf16 v[64:79], v[16:19], v[24:27], v[64:79]
    v_mfma_f32_32x32x16_bf16 v[80:95], v[20:23], v[24:27], v[80:95]
    v_mfma_f32_32x32x16_bf16 v[80:95], v[16:19], v[28:31], v[80:95]
    s_waitcnt lgkmcnt(0)
    v_mfma_f32_32x32x16_bf16 v[64:79], v[32:35], v[40:43], v[64:79]
    v_mfma_f32_32x32x16_bf16 v[80:95], v[36:39], v[40:43], v[80:95]
    v_lshlrev_b32 v10, 4, v1
    s_lshl_b32 s46, s13, 12
    s_add_u32 s46, s46, 44800
    v_add_u32 v11, s46, v10
    s_nop 6
    ds_write_b128 v11, v[64:67] offset:0
    ds_write_b128 v11, v[68:71] offset:1024
    ds_write_b128 v11, v[72:75] offset:2048
    ds_write_b128 v11, v[76:79] offset:3072
    v_mov_b32 v64, v80
    v_mov_b32 v65, v81
    v_mov_b32 v66, v82
    v_mov_b32 v67, v83
    v_mov_b32 v68, v84
    v_mov_b32 v69, v85
    v_mov_b32 v70, v86
    v_mov_b32 v71, v87
    v_mov_b32 v72, v88
    v_mov_b32 v73, v89
    v_mov_b32 v74, v90
    v_mov_b32 v75, v91
    v_mov_b32 v76, v92
    v_mov_b32 v77, v93
    v_mov_b32 v78, v94
    v_mov_b32 v79, v95
L_B_convdone:
    v_lshlrev_b32_e64 v9, 4, v1
    s_lshl_b32 s53, s14, 8
    s_lshl_b32 s54, s15, 3
    s_add_u32 s53, s53, s54
    s_lshl_b32 s54, s13, 1
    s_add_u32 s53, s53, s54
    s_lshl_b32 s53, s53, 10
    buffer_load_dwordx4 v[96:99], v9, s[8:11], s53 offen
    buffer_load_dwordx4 v[100:103], v9, s[8:11], s53 offen offset:1024
    global_load_dwordx4 v[104:107], v9, s[36:37]
    s_setprio 3
    s_xor_b32 s47, s13, 1
    s_lshl_b32 s47, s47, 12
    s_add_u32 s47, s47, 44800
    v_add_u32 v12, s47, v10
    s_mul_i32 s46, s40, 4224
    s_lshl_b32 s47, s39, 6
    s_add_u32 s46, s46, s47
    s_add_u32 s46, s46, 61184
    v_mul_u32_u24 v13, 528, v4
    v_lshl_add_u32 v13, v8, 5, v13
    v_lshl_add_u32 v13, v3, 3, v13
    v_add_u32 v13, s46, v13
    v_lshrrev_b32 v14, 5, v0
    v_and_b32_e64 v15, 31, v0
    v_mul_u32_u24 v14, 528, v14
    v_lshl_add_u32 v14, v15, 4, v14
    v_lshlrev_b32 v15, 4, v0
    s_lshl_b32 s46, s14, 5
    s_add_u32 s46, s46, s15
    s_lshl_b32 s47, s46, 13
    s_add_u32 s47, s47, 8388608
    s_add_u32 s48, s47, 4096
    s_waitcnt lgkmcnt(0)
    s_barrier
    ds_read_b128 v[16:19], v12 offset:0
    ds_read_b128 v[20:23], v12 offset:1024
    ds_read_b128 v[24:27], v12 offset:2048
    ds_read_b128 v[28:31], v12 offset:3072
    s_waitcnt lgkmcnt(3)
    v_add_f32 v64, v64, v16
    v_add_f32 v65, v65, v17
    v_add_f32 v66, v66, v18
    v_add_f32_e64 v67, v67, v19
    v_cvt_pk_bf16_f32 v32, v64, v65
    v_cvt_pk_bf16_f32 v33, v66, v67
    ds_write_b64 v13, v[32:33] offset:0
    s_waitcnt lgkmcnt(3)
    v_add_f32 v68, v68, v20
    v_add_f32 v69, v69, v21
    v_add_f32 v70, v70, v22
    v_add_f32_e64 v71, v71, v23
    v_cvt_pk_bf16_f32 v34, v68, v69
    v_cvt_pk_bf16_f32 v35, v70, v71
    ds_write_b64 v13, v[34:35] offset:128
    s_waitcnt lgkmcnt(3)
    v_add_f32 v72, v72, v24
    v_add_f32 v73, v73, v25
    v_add_f32 v74, v74, v26
    v_add_f32_e64 v75, v75, v27
    v_cvt_pk_bf16_f32 v36, v72, v73
    v_cvt_pk_bf16_f32 v37, v74, v75
    ds_write_b64 v13, v[36:37] offset:256
    s_waitcnt lgkmcnt(3)
    v_add_f32 v76, v76, v28
    v_add_f32 v77, v77, v29
    v_add_f32 v78, v78, v30
    v_add_f32_e64 v79, v79, v31
    v_cvt_pk_bf16_f32 v38, v76, v77
    v_cvt_pk_bf16_f32 v39, v78, v79
    ds_write_b64 v13, v[38:39] offset:384
    s_waitcnt lgkmcnt(0)
    s_barrier
    ds_read_b128 v[16:19], v14 offset:61184
    ds_read_b128 v[20:23], v14 offset:65408
    s_waitcnt lgkmcnt(1)
    buffer_store_dwordx4 v[16:19], v15, s[4:7], s47 offen sc1
    s_waitcnt lgkmcnt(0)
    buffer_store_dwordx4 v[20:23], v15, s[4:7], s48 offen sc1
    v_mov_b32 v108, 0
    v_mov_b32 v109, 0
    s_mov_b32 s58, 0xffff0000
    v_mov_b32 v110, 0x3f803f80
    s_waitcnt vmcnt(2)
    v_lshlrev_b32 v111, 16, v104
    v_and_b32 v112, s58, v104
    v_lshlrev_b32 v113, 16, v96
    v_and_b32 v114, s58, v96
    v_mul_f32 v113, v111, v113
    v_mul_f32_e64 v114, v112, v114
    v_cvt_pk_bf16_f32 v113, v113, v114
    v_dot2c_f32_bf16 v108, v113, v110
    v_lshlrev_b32 v115, 16, v100
    v_and_b32 v116, s58, v100
    v_mul_f32 v115, v111, v115
    v_mul_f32_e64 v116, v112, v116
    v_cvt_pk_bf16_f32 v115, v115, v116
    v_dot2c_f32_bf16 v109, v115, v110
    v_lshlrev_b32 v111, 16, v105
    v_and_b32 v112, s58, v105
    v_lshlrev_b32 v113, 16, v97
    v_and_b32 v114, s58, v97
    v_mul_f32 v113, v111, v113
    v_mul_f32_e64 v114, v112, v114
    v_cvt_pk_bf16_f32 v113, v113, v114
    v_dot2c_f32_bf16 v108, v113, v110
    v_lshlrev_b32 v115, 16, v101
    v_and_b32 v116, s58, v101
    v_mul_f32 v115, v111, v115
    v_mul_f32_e64 v116, v112, v116
    v_cvt_pk_bf16_f32 v115, v115, v116
    v_dot2c_f32_bf16 v109, v115, v110
    v_lshlrev_b32 v111, 16, v106
    v_and_b32 v112, s58, v106
    v_lshlrev_b32 v113, 16, v98
    v_and_b32 v114, s58, v98
    v_mul_f32 v113, v111, v113
    v_mul_f32_e64 v114, v112, v114
    v_cvt_pk_bf16_f32 v113, v113, v114
    v_dot2c_f32_bf16 v108, v113, v110
    v_lshlrev_b32 v115, 16, v102
    v_and_b32 v116, s58, v102
    v_mul_f32 v115, v111, v115
    v_mul_f32_e64 v116, v112, v116
    v_cvt_pk_bf16_f32 v115, v115, v116
    v_dot2c_f32_bf16 v109, v115, v110
    v_lshlrev_b32 v111, 16, v107
    v_and_b32 v112, s58, v107
    v_lshlrev_b32 v113, 16, v99
    v_and_b32 v114, s58, v99
    v_mul_f32 v113, v111, v113
    v_mul_f32_e64 v114, v112, v114
    v_cvt_pk_bf16_f32 v113, v113, v114
    v_dot2c_f32_bf16 v108, v113, v110
    v_lshlrev_b32 v115, 16, v103
    v_and_b32 v116, s58, v103
    v_mul_f32 v115, v111, v115
    v_mul_f32_e64 v116, v112, v116
    v_cvt_pk_bf16_f32 v115, v115, v116
    v_dot2c_f32_bf16 v109, v115, v110
    v_add_f32_dpp v108, v108, v108 row_shr:1 row_mask:0xf bank_mask:0xf bound_ctrl:0
    s_nop 1
    v_add_f32_dpp v109, v109, v109 row_shr:1 row_mask:0xf bank_mask:0xf bound_ctrl:0
    v_add_f32_dpp v108, v108, v108 row_shr:2 row_mask:0xf bank_mask:0xf bound_ctrl:0
    s_nop 0
    v_add_f32_dpp v109, v109, v109 row_shr:2 row_mask:0xf bank_mask:0xf bound_ctrl:0
    v_add_f32_dpp v108, v108, v108 row_shr:4 row_mask:0xf bank_mask:0xf bound_ctrl:0
    s_nop 0
    v_add_f32_dpp v109, v109, v109 row_shr:4 row_mask:0xf bank_mask:0xf bound_ctrl:0
    v_add_f32_dpp v108, v108, v108 row_shr:8 row_mask:0xf bank_mask:0xf bound_ctrl:0
    s_nop 0
    v_add_f32_dpp v109, v109, v109 row_shr:8 row_mask:0xf bank_mask:0xf bound_ctrl:0
    v_add_f32_dpp v108, v108, v108 row_bcast:15 row_mask:0xa bank_mask:0xf
    s_nop 0
    v_add_f32_dpp v109, v109, v109 row_bcast:15 row_mask:0xa bank_mask:0xf
    v_add_f32_dpp v108, v108, v108 row_bcast:31 row_mask:0xc bank_mask:0xf
    s_nop 0
    v_add_f32_dpp v109, v109, v109 row_bcast:31 row_mask:0xc bank_mask:0xf
    v_cvt_pk_bf16_f32 v108, v108, v108
    v_lshlrev_b32 v108, 16, v108
    v_mul_f32 v108, 0x3fb8aa3b, v108
    v_exp_f32 v108, -v108
    s_nop 0
    v_add_f32 v108, 1.0, v108
    v_rcp_f32 v108, v108
    s_nop 0
    v_cvt_pk_bf16_f32 v108, v108, v108
    v_lshlrev_b32_e64 v108, 16, v108
    v_cvt_pk_bf16_f32 v109, v109, v109
    v_lshlrev_b32_e64 v109, 16, v109
    v_mul_f32 v109, 0x3fb8aa3b, v109
    v_exp_f32 v109, -v109
    s_nop 0
    v_add_f32 v109, 1.0, v109
    v_rcp_f32 v109, v109
    s_nop 0
    v_cvt_pk_bf16_f32 v109, v109, v109
    v_lshlrev_b32 v109, 16, v109
    s_lshl_b32 s59, s13, 3
    s_add_u32 s59, s59, 4416
    v_mov_b32 v39, s59
    s_mov_b32 exec_lo, 0
    s_mov_b32 exec_hi, 0x80000000
    ds_write2_b32 v39, v108, v109 offset0:0 offset1:1
    s_mov_b64 exec, -1
    s_waitcnt vmcnt(0) lgkmcnt(0)
    s_barrier
    s_cmp_eq_u32 s13, 0
    s_cbranch_scc0 L_B_fin
    s_lshl_b32 s46, s46, 7
    s_add_u32 s46, s46, 131072
    v_mov_b32 v16, s12
    v_mov_b32_e64 v17, 0
    s_mov_b64 exec, 1
    buffer_store_dword v16, v17, s[4:7], s46 offen sc1
    s_mov_b64 exec, -1
    v_and_b32 v6, 7, v1
    v_lshlrev_b32_e64 v40, 2, v6
    ds_read_b32 v42, v40 offset:4416
    v_mov_b32 v43, s12
    v_lshlrev_b32_e64 v41, 3, v6
    s_lshl_b32 s59, s38, 7
    s_add_u32 s59, s59, 327680
    s_waitcnt lgkmcnt(0)
    s_mov_b64 exec, 0xff
    buffer_store_dwordx2 v[42:43], v41, s[4:7], s59 offen sc1
    s_mov_b64 exec, -1
L_B_fin:
    s_mov_b64 exec, -1
    s_cmp_eq_u32 s2, 0
    s_cbranch_scc0 L_B_noep
    s_cmp_eq_u32 s13, 0
    s_cbranch_scc0 L_B_noep
    v_lshlrev_b32 v12, 4, v1
    v_lshlrev_b32 v8, 3, v12
    v_lshlrev_b32_e64 v11, 5, v12
    s_mov_b32 s99, 0
L_epoch:
    s_mov_b32 s59, 196612
    buffer_load_dword v24, v11, s[4:7], s59 offen sc1
    s_mov_b32 s59, 229380
    buffer_load_dword v25, v11, s[4:7], s59 offen sc1
    s_mov_b32 s59, 262148
    buffer_load_dword v26, v11, s[4:7], s59 offen sc1
    s_mov_b32 s59, 294916
    buffer_load_dword v27, v11, s[4:7], s59 offen sc1
    s_mov_b32 s59, 131072
    buffer_load_dword v28, v8, s[4:7], s59 offen sc1
    s_mov_b32 s59, 139264
    buffer_load_dword v29, v8, s[4:7], s59 offen sc1
    s_mov_b32 s59, 147456
    buffer_load_dword v30, v8, s[4:7], s59 offen sc1
    s_mov_b32 s59, 155648
    buffer_load_dword v31, v8, s[4:7], s59 offen sc1
    s_waitcnt vmcnt(0)
    v_xor_b32 v24, s12, v24
    v_xor_b32 v25, s12, v25
    v_or_b32 v24, v24, v25
    v_xor_b32 v26, s12, v26
    v_or_b32 v24, v24, v26
    v_xor_b32 v27, s12, v27
    v_or_b32 v24, v24, v27
    v_xor_b32 v28, s12, v28
    v_or_b32 v24, v24, v28
    v_xor_b32 v29, s12, v29
    v_or_b32 v24, v24, v29
    v_xor_b32 v30, s12, v30
    v_or_b32 v24, v24, v30
    v_xor_b32 v31, s12, v31
    v_or_b32 v24, v24, v31
    v_cmp_ne_u32 vcc, 0, v24
    s_cbranch_vccz L_epoch_ok
    s_sleep 3
    s_add_u32 s99, s99, 1
    s_cmp_lt_u32 s99, 20000
    s_cbranch_scc1 L_epoch
L_epoch_ok:
    v_mov_b32 v9, s12
    v_mov_b32 v10, 0
    s_mov_b64 exec, 1
    buffer_store_dword v9, v10, s[4:7], 0 offen sc1
    s_mov_b64 exec, -1
L_B_noep:
    s_branch L_end
L_end:
    s_endpgm
.section .rodata,"a"
.p2align 6
.amdhsa_kernel gated_mix__ssm_conv_s5__ssm_conv_s4d__prompt_kernel
  .amdhsa_next_free_vgpr 256
  .amdhsa_next_free_sgpr 102
  .amdhsa_accum_offset 128
  .amdhsa_group_segment_fixed_size 0
  .amdhsa_kernarg_size 160
  .amdhsa_user_sgpr_count 2
  .amdhsa_user_sgpr_kernarg_segment_ptr 1
  .amdhsa_system_sgpr_workgroup_id_x 1
  .amdhsa_float_denorm_mode_32 3
.end_amdhsa_kernel
```
